```python
import torch

def _softmax(x, axis=-1):
    return torch.softmax(x, dim=axis)
def _gelu(x):
    return torch.nn.functional.gelu(x, approximate="tanh")
def _silu(x):
    return torch.nn.functional.silu(x)
def _sigmoid(x):
    return torch.sigmoid(x)
def _layernorm(x, axis=-1, eps=1e-5):
    m = x.mean(dim=axis, keepdim=True)
    v = x.var(dim=axis, keepdim=True, unbiased=False)
    return (x - m) / torch.sqrt(v + eps)
def _scatter_add(tgt, idx, src, axis=0):
    return tgt.clone().index_add_(axis, idx, src)
def _segment_sum(src, seg, n):
    out = torch.zeros((n,) + src.shape[1:], dtype=src.dtype)
    return out.index_add_(0, seg, src)
def _pad(x, pw):
    flat = tuple(v for pair in reversed(pw) for v in pair)
    return torch.nn.functional.pad(x, flat)

kernel_name = 'parallel_sum__grouped_kv_mqa__dense_activation_gelu__prompt'

def setup_inputs():

    _w = (lambda a: (lambda t: t.to(torch.bfloat16) if t.is_floating_point() else t)(torch.as_tensor(a)))
    def _A_setup():
        B, S, D, H = 1, 2048, 512, 32
        Dh = D // H
        return {
            "x": _w((lambda *s: torch.randn(*s, dtype=torch.bfloat16) * 0.05)(B, S, D)),
            "wq": _w((lambda *s: torch.randn(*s, dtype=torch.bfloat16) * 0.05)(D, H * Dh)),
            "wk": _w((lambda *s: torch.randn(*s, dtype=torch.bfloat16) * 0.05)(D, Dh)),
            "wv": _w((lambda *s: torch.randn(*s, dtype=torch.bfloat16) * 0.05)(D, Dh)),
            "wo": _w((lambda *s: torch.randn(*s, dtype=torch.bfloat16) * 0.05)(H * Dh, D)),
        }
    _A_in = _A_setup()

    def _B_setup():
        B, S, D, F = 1, 2048, 512, 1376
        return {
            "x": _w((lambda *s: torch.randn(*s, dtype=torch.bfloat16) * 0.05)(B, S, D)),
            "w1": _w((lambda *s: torch.randn(*s, dtype=torch.bfloat16) * 0.8)(D, F) * (D ** -0.5)),
            "b1": _w((lambda *s: torch.randn(*s, dtype=torch.bfloat16) * 12.8)(F) * 0.01),
            "w2": _w((lambda *s: torch.randn(*s, dtype=torch.bfloat16) * 0.8)(F, D) * (F ** -0.5)),
            "b2": _w((lambda *s: torch.randn(*s, dtype=torch.bfloat16) * 12.8)(D) * 0.01),
        }
    _B_in = _B_setup()

    return {
        "A_x": _A_in["x"],
        "A_wq": _A_in["wq"],
        "A_wk": _A_in["wk"],
        "A_wv": _A_in["wv"],
        "A_wo": _A_in["wo"],
        "B_x": _B_in["x"],
        "B_w1": _B_in["w1"],
        "B_b1": _B_in["b1"],
        "B_w2": _B_in["w2"],
        "B_b2": _B_in["b2"],
    }

def reference(A_x, A_wq, A_wk, A_wv, A_wo, B_x, B_w1, B_b1, B_w2, B_b2):
    def _A_ref(x, wq, wk, wv, wo):
        B, S, D = x.shape
        H = 32
        Dh = D // H
        q = (lambda x, *d: x.permute(*d))((x @ wq).reshape(B, S, H, Dh), 0, 2, 1, 3)
        k = x @ wk
        v = x @ wv
        scores = torch.einsum("bhqd,bkd->bhqk", q, k) * (Dh ** -0.5)
        p = _softmax(scores, axis=-1)
        o = torch.einsum("bhqk,bkd->bhqd", p, v)
        return (lambda x, *d: x.permute(*d))(o, 0, 2, 1, 3).reshape(B, S, H * Dh) @ wo

    def _B_ref(x, w1, b1, w2, b2):
        h = torch.einsum("bsd,df->bsf", x, w1) + b1
        h = _gelu(h)
        return torch.einsum("bsf,fd->bsd", h, w2) + b2

    x = A_x
    xn = _layernorm(x, axis=-1)
    return x + _A_ref(xn, A_wq, A_wk, A_wv, A_wo) + _B_ref(xn, B_w1, B_b1, B_w2, B_b2)
```

```asm
; @launch grid=(256,1,1) block=(512,1,1) lds=163840
.amdgcn_target "amdgcn-amd-amdhsa--gfx950"
.text
.globl parallel_sum__grouped_kv_mqa__dense_activation_gelu__prompt_kernel
.p2align 8
.type parallel_sum__grouped_kv_mqa__dense_activation_gelu__prompt_kernel,@function
parallel_sum__grouped_kv_mqa__dense_activation_gelu__prompt_kernel:
    s_cmp_ge_u32 s2, 256
    s_cbranch_scc1 L_end
    s_load_dwordx16 s[16:31], s[0:1], 0
    s_load_dwordx8 s[32:39], s[0:1], 64
    s_load_dwordx2 s[40:41], s[0:1], 96
    v_lshrrev_b32 v3, 6, v0
    v_and_b32 v1, 63, v0
    v_readfirstlane_b32 s3, v3
    v_lshlrev_b32 v2, 4, v1
    s_bfe_u32 s9, s2, 0x20001
    s_lshl_b32 s9, s9, 3
    s_bfe_u32 s10, s2, 0x30003
    s_or_b32 s4, s9, s10
    s_and_b32 s9, s2, 1
    s_lshl_b32 s9, s9, 2
    s_lshr_b32 s10, s2, 6
    s_or_b32 s5, s9, s10
    v_lshrrev_b32 v4, 4, v1
    v_and_b32 v5, 15, v1
    s_lshl_b32 s9, s5, 1
    s_add_u32 s9, s9, s3
    s_and_b32 s9, s9, 7
    s_lshl_b32 s9, s9, 3
    v_add_u32 v20, s9, v4
    v_lshlrev_b32 v21, 10, v20
    v_lshl_add_u32 v21, v5, 4, v21
    s_lshl_b32 s9, s4, 16
    s_add_u32 s10, s9, 4096
    s_mov_b32 s46, 2097152
    s_mov_b32 s47, 0x00020000
    s_waitcnt lgkmcnt(0)
    s_mov_b32 s44, s16
    s_mov_b32 s45, s17
    buffer_load_dwordx4 v[128:131], v21, s[44:47], s9 offen offset:0
    buffer_load_dwordx4 v[132:135], v21, s[44:47], s9 offen offset:256
    buffer_load_dwordx4 v[136:139], v21, s[44:47], s9 offen offset:512
    buffer_load_dwordx4 v[140:143], v21, s[44:47], s9 offen offset:768
    buffer_load_dwordx4 v[144:147], v21, s[44:47], s10 offen offset:0
    buffer_load_dwordx4 v[148:151], v21, s[44:47], s10 offen offset:256
    buffer_load_dwordx4 v[152:155], v21, s[44:47], s10 offen offset:512
    buffer_load_dwordx4 v[156:159], v21, s[44:47], s10 offen offset:768
    s_barrier
    s_cmp_lt_u32 s5, 4
    s_cselect_b32 s9, s20, s22
    s_cselect_b32 s10, s21, s23
    s_mov_b32 s52, s9
    s_mov_b32 s53, s10
    s_mov_b32 s54, 16384
    s_mov_b32 s55, 0x00020000
    s_lshl_b32 s9, s3, 11
    s_add_u32 m0, s9, 143360
    s_nop 0
    buffer_load_dwordx4 v2, s[52:55], s9 offen lds
    buffer_load_dwordx4 v2, s[52:55], s9 offen offset:1024 lds
    s_mov_b32 s13, 0x3f803f80
    s_mul_i32 s9, s5, 5
    s_min_u32 s10, s5, 3
    s_add_u32 s9, s9, s10
    s_add_u32 s9, s9, s3
    s_sub_u32 s12, s9, 2
    s_lshl_b32 s9, s5, 1
    s_add_u32 s9, s9, s3
    s_cmp_lt_u32 s3, 2
    s_cselect_b32 s12, s9, s12
    s_mov_b32 s11, 2752
    s_cselect_b32 s11, 1024, s11
    s_mov_b32 s50, 1409024
    s_cselect_b32 s50, 524288, s50
    s_cselect_b32 s48, s18, s28
    s_cselect_b32 s49, s19, s29
    s_mov_b32 s51, 0x00020000
    s_cmp_ge_u32 s5, 3
    s_cselect_b32 s9, 1, 0
    s_cmp_eq_u32 s3, 7
    s_cselect_b32 s9, s9, 0
    s_cmp_eq_u32 s9, 1
    s_cselect_b32 s12, 63, s12
    s_cselect_b32 s50, 0, s50
    s_lshl_b32 s7, s11, 4
    v_lshrrev_b32 v11, 2, v1
    v_mul_lo_u32 v11, v11, s11
    v_and_b32 v15, 3, v1
    v_lshl_add_u32 v11, v15, 4, v11
    s_lshl_b32 s9, s12, 6
    v_add_u32 v11, s9, v11
    s_and_b32 s19, s4, 3
    s_mul_i32 s10, s7, 8
    s_xor_b32 s9, s19, 0
    s_mul_i32 s26, s9, s10
    s_xor_b32 s9, s19, 1
    s_mul_i32 s27, s9, s10
    s_xor_b32 s9, s19, 2
    s_mul_i32 s38, s9, s10
    s_xor_b32 s9, s19, 3
    s_mul_i32 s39, s9, s10
    s_lshl_b32 s99, s3, 13
    s_add_u32 s99, s99, 50176
    s_cmp_eq_u32 s3, 0
    s_cselect_b32 s99, 117760, s99
    s_cmp_eq_u32 s3, 1
    s_cselect_b32 s99, 126464, s99
    s_add_u32 m0, s99, 0
    s_mov_b32 s8, s26
    buffer_load_dwordx4 v11, s[48:51], s8 offen lds
    s_add_u32 m0, s99, 1024
    s_add_u32 s8, s8, s7
    buffer_load_dwordx4 v11, s[48:51], s8 offen lds
    s_add_u32 m0, s99, 2048
    s_add_u32 s8, s8, s7
    buffer_load_dwordx4 v11, s[48:51], s8 offen lds
    s_add_u32 m0, s99, 3072
    s_add_u32 s8, s8, s7
    buffer_load_dwordx4 v11, s[48:51], s8 offen lds
    s_mov_b32 s56, s40
    s_mov_b32 s57, s41
    s_mov_b32 s58, 16777216
    s_mov_b32 s59, 0x00020000
    s_load_dword s6, s[40:41], 0
    s_and_b32 s9, s5, 3
    s_lshl_b32 s10, s4, 2
    s_add_u32 s92, s9, s10
    s_lshr_b32 s93, s5, 2
    s_bfe_u32 s94, s3, 0x10001
    s_and_b32 s95, s3, 1
    s_lshr_b32 s96, s3, 2
    s_lshl_b32 s9, s4, 16
    s_add_u32 s9, s9, 8388608
    s_add_u32 s9, s40, s9
    s_addc_u32 s10, s41, 0
    s_mov_b32 s64, s9
    s_mov_b32 s65, s10
    s_mov_b32 s66, 65536
    s_mov_b32 s67, 0x00020000
    s_lshl_b32 s9, s5, 2
    s_lshl_b32 s10, s94, 1
    s_add_u32 s9, s9, s10
    s_add_u32 s9, s9, s96
    s_lshl_b32 s9, s9, 1
    s_add_u32 s9, s9, s95
    s_lshl_b32 s43, s9, 10
    s_mul_i32 s9, s4, 180224
    s_add_u32 s9, s9, 1048576
    s_add_u32 s9, s40, s9
    s_addc_u32 s10, s41, 0
    s_mov_b32 s60, s9
    s_mov_b32 s61, s10
    s_mov_b32 s62, 176128
    s_mov_b32 s63, 0x00020000
    v_and_b32 v15, 3, v1
    v_lshlrev_b32 v13, 3, v15
    v_bfe_u32 v15, v1, 2, 2
    v_lshl_add_u32 v13, v15, 6, v13
    v_bfe_u32 v15, v1, 4, 1
    v_lshl_add_u32 v13, v15, 5, v13
    v_mov_b32 v17, v13
    v_lshrrev_b32 v16, 5, v1
    v_lshl_add_u32 v13, v16, 9, v13
    v_add_u32 v13, s99, v13
    v_and_b32 v18, 31, v1
    v_mul_u32_u24 v14, 1040, v18
    v_lshl_add_u32 v14, v16, 4, v14
    s_xor_b32 s9, s19, 0
    s_mul_i32 s9, s9, 256
    v_add_u32 v6, s9, v14
    s_xor_b32 s9, s19, 1
    s_mul_i32 s9, s9, 256
    v_add_u32 v7, s9, v14
    s_xor_b32 s9, s19, 2
    s_mul_i32 s9, s9, 256
    v_add_u32 v8, s9, v14
    s_xor_b32 s9, s19, 3
    s_mul_i32 s9, s9, 256
    v_add_u32 v9, s9, v14
    v_xor_b32 v15, v4, v1
    v_and_b32 v15, 1, v15
    v_cmp_eq_u32 vcc, 0, v15
    v_mov_b32 v15, s13
    s_nop 0
    v_cndmask_b32 v88, 0, v15, vcc
    v_cndmask_b32 v89, 0, v15, vcc
    v_cndmask_b32 v90, 0, v15, vcc
    v_cndmask_b32 v91, 0, v15, vcc
    v_mul_u32_u24 v21, 1040, v20
    v_lshl_add_u32 v21, v5, 4, v21
    v_lshlrev_b32 v20, 2, v20
    v_add_u32 v20, 159744, v20
    s_waitcnt vmcnt(13)
    ds_write_b128 v21, v[128:131] offset:0
    v_dot2_f32_bf16 v64, v128, s13, 0
    v_dot2_f32_bf16 v66, v128, v128, 0
    v_dot2_f32_bf16 v64, v129, s13, v64
    v_dot2_f32_bf16 v66, v129, v129, v66
    v_dot2_f32_bf16 v64, v130, s13, v64
    v_dot2_f32_bf16 v66, v130, v130, v66
    v_dot2_f32_bf16 v64, v131, s13, v64
    v_dot2_f32_bf16 v66, v131, v131, v66
    s_waitcnt vmcnt(12)
    ds_write_b128 v21, v[132:135] offset:256
    v_dot2_f32_bf16 v64, v132, s13, v64
    v_dot2_f32_bf16 v66, v132, v132, v66
    v_dot2_f32_bf16 v64, v133, s13, v64
    v_dot2_f32_bf16 v66, v133, v133, v66
    v_dot2_f32_bf16 v64, v134, s13, v64
    v_dot2_f32_bf16 v66, v134, v134, v66
    v_dot2_f32_bf16 v64, v135, s13, v64
    v_dot2_f32_bf16 v66, v135, v135, v66
    s_waitcnt vmcnt(11)
    ds_write_b128 v21, v[136:139] offset:512
    v_dot2_f32_bf16 v64, v136, s13, v64
    v_dot2_f32_bf16 v66, v136, v136, v66
    v_dot2_f32_bf16 v64, v137, s13, v64
    v_dot2_f32_bf16 v66, v137, v137, v66
    v_dot2_f32_bf16 v64, v138, s13, v64
    v_dot2_f32_bf16 v66, v138, v138, v66
    v_dot2_f32_bf16 v64, v139, s13, v64
    v_dot2_f32_bf16 v66, v139, v139, v66
    s_waitcnt vmcnt(10)
    ds_write_b128 v21, v[140:143] offset:768
    v_dot2_f32_bf16 v64, v140, s13, v64
    v_dot2_f32_bf16 v66, v140, v140, v66
    v_dot2_f32_bf16 v64, v141, s13, v64
    v_dot2_f32_bf16 v66, v141, v141, v66
    v_dot2_f32_bf16 v64, v142, s13, v64
    v_dot2_f32_bf16 v66, v142, v142, v66
    v_dot2_f32_bf16 v64, v143, s13, v64
    v_dot2_f32_bf16 v66, v143, v143, v66
    s_waitcnt vmcnt(9)
    ds_write_b128 v21, v[144:147] offset:4160
    v_dot2_f32_bf16 v72, v144, s13, 0
    v_dot2_f32_bf16 v74, v144, v144, 0
    v_dot2_f32_bf16 v72, v145, s13, v72
    v_dot2_f32_bf16 v74, v145, v145, v74
    v_dot2_f32_bf16 v72, v146, s13, v72
    v_dot2_f32_bf16 v74, v146, v146, v74
    v_dot2_f32_bf16 v72, v147, s13, v72
    v_dot2_f32_bf16 v74, v147, v147, v74
    s_waitcnt vmcnt(8)
    ds_write_b128 v21, v[148:151] offset:4416
    v_dot2_f32_bf16 v72, v148, s13, v72
    v_dot2_f32_bf16 v74, v148, v148, v74
    v_dot2_f32_bf16 v72, v149, s13, v72
    v_dot2_f32_bf16 v74, v149, v149, v74
    v_dot2_f32_bf16 v72, v150, s13, v72
    v_dot2_f32_bf16 v74, v150, v150, v74
    v_dot2_f32_bf16 v72, v151, s13, v72
    v_dot2_f32_bf16 v74, v151, v151, v74
    s_waitcnt vmcnt(7)
    ds_write_b128 v21, v[152:155] offset:4672
    v_dot2_f32_bf16 v72, v152, s13, v72
    v_dot2_f32_bf16 v74, v152, v152, v74
    v_dot2_f32_bf16 v72, v153, s13, v72
    v_dot2_f32_bf16 v74, v153, v153, v74
    v_dot2_f32_bf16 v72, v154, s13, v72
    v_dot2_f32_bf16 v74, v154, v154, v74
    v_dot2_f32_bf16 v72, v155, s13, v72
    v_dot2_f32_bf16 v74, v155, v155, v74
    s_waitcnt vmcnt(6)
    ds_write_b128 v21, v[156:159] offset:4928
    v_dot2_f32_bf16 v72, v156, s13, v72
    v_dot2_f32_bf16 v74, v156, v156, v74
    v_dot2_f32_bf16 v72, v157, s13, v72
    v_dot2_f32_bf16 v74, v157, v157, v74
    v_dot2_f32_bf16 v72, v158, s13, v72
    v_dot2_f32_bf16 v74, v158, v158, v74
    v_dot2_f32_bf16 v72, v159, s13, v72
    v_dot2_f32_bf16 v74, v159, v159, v74
    v_add_f32_dpp v65, v64, v64 row_ror:8 row_mask:0xf bank_mask:0xf
    v_add_f32_dpp v67, v66, v66 row_ror:8 row_mask:0xf bank_mask:0xf
    v_add_f32_dpp v73, v72, v72 row_ror:8 row_mask:0xf bank_mask:0xf
    v_add_f32_dpp v75, v74, v74 row_ror:8 row_mask:0xf bank_mask:0xf
    v_add_f32_dpp v64, v65, v65 row_ror:4 row_mask:0xf bank_mask:0xf
    v_add_f32_dpp v66, v67, v67 row_ror:4 row_mask:0xf bank_mask:0xf
    v_add_f32_dpp v72, v73, v73 row_ror:4 row_mask:0xf bank_mask:0xf
    v_add_f32_dpp v74, v75, v75 row_ror:4 row_mask:0xf bank_mask:0xf
    v_add_f32_dpp v65, v64, v64 row_ror:2 row_mask:0xf bank_mask:0xf
    v_add_f32_dpp v67, v66, v66 row_ror:2 row_mask:0xf bank_mask:0xf
    v_add_f32_dpp v73, v72, v72 row_ror:2 row_mask:0xf bank_mask:0xf
    v_add_f32_dpp v75, v74, v74 row_ror:2 row_mask:0xf bank_mask:0xf
    v_add_f32_dpp v64, v65, v65 row_ror:1 row_mask:0xf bank_mask:0xf
    v_add_f32_dpp v66, v67, v67 row_ror:1 row_mask:0xf bank_mask:0xf
    v_add_f32_dpp v72, v73, v73 row_ror:1 row_mask:0xf bank_mask:0xf
    v_add_f32_dpp v74, v75, v75 row_ror:1 row_mask:0xf bank_mask:0xf
    v_mul_f32 v68, 0xbb000000, v64
    v_mul_f32 v69, 0x3b000000, v66
    v_mul_f32 v76, 0xbb000000, v72
    v_mul_f32 v77, 0x3b000000, v74
    v_fma_f32 v69, -v68, v68, v69
    ds_write_b32 v20, v68 offset:256
    v_max_f32 v69, 0, v69
    v_add_f32 v69, 0x3727c5ac, v69
    v_rsq_f32 v69, v69
    v_fma_f32 v77, -v76, v76, v77
    ds_write_b32 v20, v76 offset:272
    v_max_f32 v77, 0, v77
    v_add_f32 v77, 0x3727c5ac, v77
    v_rsq_f32 v77, v77
    ds_write_b32 v20, v69 offset:0
    ds_write_b32 v20, v77 offset:16
    s_add_u32 m0, s99, 4096
    s_add_u32 s8, s8, s7
    buffer_load_dwordx4 v11, s[48:51], s8 offen lds
    s_add_u32 m0, s99, 5120
    s_add_u32 s8, s8, s7
    buffer_load_dwordx4 v11, s[48:51], s8 offen lds
    s_add_u32 m0, s99, 6144
    s_add_u32 s8, s8, s7
    buffer_load_dwordx4 v11, s[48:51], s8 offen lds
    s_add_u32 m0, s99, 7168
    s_add_u32 s8, s8, s7
    buffer_load_dwordx4 v11, s[48:51], s8 offen lds
    s_waitcnt vmcnt(8)
    s_waitcnt lgkmcnt(0)
    s_barrier
    s_mul_i32 s6, s6, 0x9E3779B1
    s_add_u32 s6, s6, 0x7F4A7C15
    s_cmp_lg_u32 s3, 0
    s_cbranch_scc1 L_kloop_2
    s_setprio 3
    s_and_b32 s9, s5, 3
    s_lshl_b32 s9, s9, 4
    v_add_u32 v20, s9, v5
    v_mul_u32_u24 v21, 1040, v20
    v_lshl_add_u32 v21, v4, 4, v21
    v_lshrrev_b32 v22, 2, v5
    v_lshl_add_u32 v22, v4, 3, v22
    v_lshlrev_b32 v22, 5, v22
    v_and_b32 v15, 3, v1
    v_lshl_add_u32 v22, v15, 3, v22
    v_add_u32 v22, 143360, v22
    ds_read_b128 v[128:131], v21 offset:0
    ds_read_b64_tr_b16 v[132:133], v22 offset:0
    ds_read_b64_tr_b16 v[134:135], v22 offset:128
    ds_read_b128 v[136:139], v21 offset:64
    ds_read_b64_tr_b16 v[140:141], v22 offset:1024
    ds_read_b64_tr_b16 v[142:143], v22 offset:1152
    ds_read_b128 v[144:147], v21 offset:128
    ds_read_b64_tr_b16 v[148:149], v22 offset:2048
    ds_read_b64_tr_b16 v[150:151], v22 offset:2176
    ds_read_b128 v[152:155], v21 offset:192
    ds_read_b64_tr_b16 v[156:157], v22 offset:3072
    ds_read_b64_tr_b16 v[158:159], v22 offset:3200
    ds_read_b128 v[160:163], v21 offset:256
    ds_read_b64_tr_b16 v[164:165], v22 offset:4096
    ds_read_b64_tr_b16 v[166:167], v22 offset:4224
    ds_read_b128 v[168:171], v21 offset:320
    ds_read_b64_tr_b16 v[172:173], v22 offset:5120
    ds_read_b64_tr_b16 v[174:175], v22 offset:5248
    ds_read_b128 v[176:179], v21 offset:384
    ds_read_b64_tr_b16 v[180:181], v22 offset:6144
    ds_read_b64_tr_b16 v[182:183], v22 offset:6272
    ds_read_b128 v[184:187], v21 offset:448
    ds_read_b64_tr_b16 v[188:189], v22 offset:7168
    ds_read_b64_tr_b16 v[190:191], v22 offset:7296
    ds_read_b128 v[192:195], v21 offset:512
    ds_read_b64_tr_b16 v[196:197], v22 offset:8192
    ds_read_b64_tr_b16 v[198:199], v22 offset:8320
    ds_read_b128 v[200:203], v21 offset:576
    ds_read_b64_tr_b16 v[204:205], v22 offset:9216
    ds_read_b64_tr_b16 v[206:207], v22 offset:9344
    ds_read_b128 v[208:211], v21 offset:640
    ds_read_b64_tr_b16 v[212:213], v22 offset:10240
    ds_read_b64_tr_b16 v[214:215], v22 offset:10368
    ds_read_b128 v[216:219], v21 offset:704
    ds_read_b64_tr_b16 v[220:221], v22 offset:11264
    ds_read_b64_tr_b16 v[222:223], v22 offset:11392
    ds_read_b128 v[224:227], v21 offset:768
    ds_read_b64_tr_b16 v[228:229], v22 offset:12288
    ds_read_b64_tr_b16 v[230:231], v22 offset:12416
    ds_read_b128 v[232:235], v21 offset:832
    ds_read_b64_tr_b16 v[236:237], v22 offset:13312
    ds_read_b64_tr_b16 v[238:239], v22 offset:13440
    ds_read_b128 v[240:243], v21 offset:896
    ds_read_b64_tr_b16 v[244:245], v22 offset:14336
    ds_read_b64_tr_b16 v[246:247], v22 offset:14464
    ds_read_b128 v[248:251], v21 offset:960
    ds_read_b64_tr_b16 v[252:253], v22 offset:15360
    ds_read_b64_tr_b16 v[254:255], v22 offset:15488
    v_mov_b32 v68, -1
    v_mov_b32 v69, -1
    v_mov_b32 v70, -1
    v_mov_b32 v71, -1
    v_mov_b32 v64, s13
    v_mov_b32 v65, s13
    v_mov_b32 v66, s13
    v_mov_b32 v67, s13
    v_add_u32 v23, 0x1000, v2
    s_lshl_b32 s9, s5, 13
    buffer_store_dwordx4 v[68:71], v2, s[64:67], s9 offen offset:0 sc1
    buffer_store_dwordx4 v[68:71], v2, s[64:67], s9 offen offset:1024 sc1
    buffer_store_dwordx4 v[68:71], v2, s[64:67], s9 offen offset:2048 sc1
    buffer_store_dwordx4 v[68:71], v2, s[64:67], s9 offen offset:3072 sc1
    buffer_store_dwordx4 v[68:71], v23, s[64:67], s9 offen offset:0 sc1
    buffer_store_dwordx4 v[68:71], v23, s[64:67], s9 offen offset:1024 sc1
    buffer_store_dwordx4 v[68:71], v23, s[64:67], s9 offen offset:2048 sc1
    buffer_store_dwordx4 v[68:71], v23, s[64:67], s9 offen offset:3072 sc1
    v_bfe_u32 v24, v1, 4, 1
    v_lshrrev_b32 v25, 5, v1
    s_cmp_lg_u32 s93, 0
    s_cbranch_scc1 L_kvV_3
    v_lshlrev_b32 v26, 2, v20
    v_add_u32 v26, 159744, v26
    s_lshr_b32 s9, s92, 1
    s_lshl_b32 s9, s9, 10
    s_and_b32 s10, s92, 1
    s_lshl_b32 s10, s10, 8
    s_add_u32 s9, s9, s10
    s_add_u32 s9, s9, 65536
    v_lshlrev_b32 v24, 9, v24
    v_lshl_add_u32 v24, v5, 4, v24
    v_lshl_add_u32 v24, v25, 3, v24
    ds_read_b32 v27, v26
    ds_read_b32 v28, v26 offset:256
    s_waitcnt lgkmcnt(15)
    v_mfma_f32_16x16x32_bf16 v[72:75], v[132:135], v[128:131], 0
    v_mfma_f32_16x16x32_bf16 v[76:79], v[132:135], v[64:67], 0
    v_mfma_f32_16x16x32_bf16 v[72:75], v[140:143], v[136:139], v[72:75]
    v_mfma_f32_16x16x32_bf16 v[76:79], v[140:143], v[64:67], v[76:79]
    v_mfma_f32_16x16x32_bf16 v[72:75], v[148:151], v[144:147], v[72:75]
    v_mfma_f32_16x16x32_bf16 v[76:79], v[148:151], v[64:67], v[76:79]
    v_mfma_f32_16x16x32_bf16 v[72:75], v[156:159], v[152:155], v[72:75]
    v_mfma_f32_16x16x32_bf16 v[76:79], v[156:159], v[64:67], v[76:79]
    v_mfma_f32_16x16x32_bf16 v[72:75], v[164:167], v[160:163], v[72:75]
    v_mfma_f32_16x16x32_bf16 v[76:79], v[164:167], v[64:67], v[76:79]
    v_mfma_f32_16x16x32_bf16 v[72:75], v[172:175], v[168:171], v[72:75]
    v_mfma_f32_16x16x32_bf16 v[76:79], v[172:175], v[64:67], v[76:79]
    v_mfma_f32_16x16x32_bf16 v[72:75], v[180:183], v[176:179], v[72:75]
    v_mfma_f32_16x16x32_bf16 v[76:79], v[180:183], v[64:67], v[76:79]
    v_mfma_f32_16x16x32_bf16 v[72:75], v[188:191], v[184:187], v[72:75]
    v_mfma_f32_16x16x32_bf16 v[76:79], v[188:191], v[64:67], v[76:79]
    v_mfma_f32_16x16x32_bf16 v[72:75], v[196:199], v[192:195], v[72:75]
    v_mfma_f32_16x16x32_bf16 v[76:79], v[196:199], v[64:67], v[76:79]
    v_mfma_f32_16x16x32_bf16 v[72:75], v[204:207], v[200:203], v[72:75]
    v_mfma_f32_16x16x32_bf16 v[76:79], v[204:207], v[64:67], v[76:79]
    v_mfma_f32_16x16x32_bf16 v[72:75], v[212:215], v[208:211], v[72:75]
    v_mfma_f32_16x16x32_bf16 v[76:79], v[212:215], v[64:67], v[76:79]
    s_waitcnt lgkmcnt(14)
    v_mfma_f32_16x16x32_bf16 v[72:75], v[220:223], v[216:219], v[72:75]
    v_mfma_f32_16x16x32_bf16 v[76:79], v[220:223], v[64:67], v[76:79]
    s_waitcnt lgkmcnt(11)
    v_mfma_f32_16x16x32_bf16 v[72:75], v[228:231], v[224:227], v[72:75]
    v_mfma_f32_16x16x32_bf16 v[76:79], v[228:231], v[64:67], v[76:79]
    s_waitcnt lgkmcnt(8)
    v_mfma_f32_16x16x32_bf16 v[72:75], v[236:239], v[232:235], v[72:75]
    v_mfma_f32_16x16x32_bf16 v[76:79], v[236:239], v[64:67], v[76:79]
    s_waitcnt lgkmcnt(5)
    v_mfma_f32_16x16x32_bf16 v[72:75], v[244:247], v[240:243], v[72:75]
    v_mfma_f32_16x16x32_bf16 v[76:79], v[244:247], v[64:67], v[76:79]
    s_waitcnt lgkmcnt(2)
    v_mfma_f32_16x16x32_bf16 v[72:75], v[252:255], v[248:251], v[72:75]
    v_mfma_f32_16x16x32_bf16 v[76:79], v[252:255], v[64:67], v[76:79]
    s_waitcnt lgkmcnt(0)
    s_nop 6
    v_fmac_f32 v72, v28, v76
    v_fmac_f32 v73, v28, v77
    v_fmac_f32 v74, v28, v78
    v_fmac_f32 v75, v28, v79
    v_mul_f32 v72, v72, v27
    v_mul_f32 v73, v73, v27
    v_mul_f32 v74, v74, v27
    v_mul_f32 v75, v75, v27
    v_cvt_pk_bf16_f32 v30, v72, v73
    v_cvt_pk_bf16_f32 v31, v74, v75
    buffer_store_dwordx2 v[30:31], v24, s[56:59], s9 offen sc1
    v_dot2_f32_bf16 v22, v30, v30, 0
    v_dot2_f32_bf16 v22, v31, v31, v22
    s_nop 2
    v_mov_b32 v23, v22
    s_nop 1
    v_permlane32_swap_b32 v22, v23
    v_add_f32 v22, v22, v23
    v_mov_b32 v23, v22
    s_nop 1
    v_permlane16_swap_b32 v22, v23
    v_add_f32 v22, v22, v23
    s_nop 1
    v_max_f32_dpp v23, v22, v22 row_ror:8 row_mask:0xf bank_mask:0xf
    v_mov_b32 v22, v23
    s_nop 1
    v_max_f32_dpp v23, v22, v22 row_ror:4 row_mask:0xf bank_mask:0xf
    v_mov_b32 v22, v23
    s_nop 1
    v_max_f32_dpp v23, v22, v22 row_ror:2 row_mask:0xf bank_mask:0xf
    v_mov_b32 v22, v23
    s_nop 1
    v_max_f32_dpp v23, v22, v22 row_ror:1 row_mask:0xf bank_mask:0xf
    v_mov_b32 v22, v23
    v_mov_b32 v63, v22
    s_branch L_kvpub_4
L_kvV_3:
    s_and_b32 s9, s5, 3
    s_lshl_b32 s9, s9, 6
    s_add_u32 s9, s9, 159744
    v_lshl_add_u32 v26, v4, 4, s9
    s_lshl_b32 s9, s92, 9
    s_add_u32 s9, s9, 131072
    v_lshlrev_b32 v24, 8, v24
    v_lshl_add_u32 v24, v5, 4, v24
    v_lshl_add_u32 v24, v25, 3, v24
    ds_read_b128 v[80:83], v26
    ds_read_b128 v[84:87], v26 offset:256
    s_waitcnt lgkmcnt(15)
    v_mfma_f32_16x16x32_bf16 v[72:75], v[128:131], v[132:135], 0
    v_mfma_f32_16x16x32_bf16 v[76:79], v[64:67], v[132:135], 0
    v_mfma_f32_16x16x32_bf16 v[72:75], v[136:139], v[140:143], v[72:75]
    v_mfma_f32_16x16x32_bf16 v[76:79], v[64:67], v[140:143], v[76:79]
    v_mfma_f32_16x16x32_bf16 v[72:75], v[144:147], v[148:151], v[72:75]
    v_mfma_f32_16x16x32_bf16 v[76:79], v[64:67], v[148:151], v[76:79]
    v_mfma_f32_16x16x32_bf16 v[72:75], v[152:155], v[156:159], v[72:75]
    v_mfma_f32_16x16x32_bf16 v[76:79], v[64:67], v[156:159], v[76:79]
    v_mfma_f32_16x16x32_bf16 v[72:75], v[160:163], v[164:167], v[72:75]
    v_mfma_f32_16x16x32_bf16 v[76:79], v[64:67], v[164:167], v[76:79]
    v_mfma_f32_16x16x32_bf16 v[72:75], v[168:171], v[172:175], v[72:75]
    v_mfma_f32_16x16x32_bf16 v[76:79], v[64:67], v[172:175], v[76:79]
    v_mfma_f32_16x16x32_bf16 v[72:75], v[176:179], v[180:183], v[72:75]
    v_mfma_f32_16x16x32_bf16 v[76:79], v[64:67], v[180:183], v[76:79]
    v_mfma_f32_16x16x32_bf16 v[72:75], v[184:187], v[188:191], v[72:75]
    v_mfma_f32_16x16x32_bf16 v[76:79], v[64:67], v[188:191], v[76:79]
    v_mfma_f32_16x16x32_bf16 v[72:75], v[192:195], v[196:199], v[72:75]
    v_mfma_f32_16x16x32_bf16 v[76:79], v[64:67], v[196:199], v[76:79]
    v_mfma_f32_16x16x32_bf16 v[72:75], v[200:203], v[204:207], v[72:75]
    v_mfma_f32_16x16x32_bf16 v[76:79], v[64:67], v[204:207], v[76:79]
    v_mfma_f32_16x16x32_bf16 v[72:75], v[208:211], v[212:215], v[72:75]
    v_mfma_f32_16x16x32_bf16 v[76:79], v[64:67], v[212:215], v[76:79]
    s_waitcnt lgkmcnt(14)
    v_mfma_f32_16x16x32_bf16 v[72:75], v[216:219], v[220:223], v[72:75]
    v_mfma_f32_16x16x32_bf16 v[76:79], v[64:67], v[220:223], v[76:79]
    s_waitcnt lgkmcnt(11)
    v_mfma_f32_16x16x32_bf16 v[72:75], v[224:227], v[228:231], v[72:75]
    v_mfma_f32_16x16x32_bf16 v[76:79], v[64:67], v[228:231], v[76:79]
    s_waitcnt lgkmcnt(8)
    v_mfma_f32_16x16x32_bf16 v[72:75], v[232:235], v[236:239], v[72:75]
    v_mfma_f32_16x16x32_bf16 v[76:79], v[64:67], v[236:239], v[76:79]
    s_waitcnt lgkmcnt(5)
    v_mfma_f32_16x16x32_bf16 v[72:75], v[240:243], v[244:247], v[72:75]
    v_mfma_f32_16x16x32_bf16 v[76:79], v[64:67], v[244:247], v[76:79]
    s_waitcnt lgkmcnt(2)
    v_mfma_f32_16x16x32_bf16 v[72:75], v[248:251], v[252:255], v[72:75]
    v_mfma_f32_16x16x32_bf16 v[76:79], v[64:67], v[252:255], v[76:79]
    s_waitcnt lgkmcnt(0)
    s_nop 6
    v_fmac_f32 v72, v84, v76
    v_fmac_f32 v73, v85, v77
    v_fmac_f32 v74, v86, v78
    v_fmac_f32 v75, v87, v79
    v_mul_f32 v72, v72, v80
    v_mul_f32 v73, v73, v81
    v_mul_f32 v74, v74, v82
    v_mul_f32 v75, v75, v83
    v_cvt_pk_bf16_f32 v30, v72, v73
    v_cvt_pk_bf16_f32 v31, v74, v75
    buffer_store_dwordx2 v[30:31], v24, s[56:59], s9 offen sc1
    v_mov_b32 v63, 0
L_kvpub_4:
    s_nop 1
    v_mov_b32 v62, s6
    s_lshl_b32 s9, s92, 1
    s_add_u32 s9, s9, s93
    s_lshl_b32 s9, s9, 3
    s_add_u32 s9, s9, 4096
    s_waitcnt vmcnt(0)
    s_mov_b64 exec, 1
    buffer_store_dwordx2 v[62:63], off, s[56:59], s9 sc1
    s_mov_b64 exec, -1
    s_setprio 0
L_kloop_2:
    s_nop 2
    s_cmp_eq_u32 s12, 63
    s_cbranch_scc1 L_skip2_5
    ds_read_b128 v[140:143], v6 offset:0
    ds_read_b128 v[144:147], v6 offset:33280
    s_waitcnt vmcnt(7)
    ds_read_b64_tr_b16 v[128:129], v13 offset:0
    ds_read_b64_tr_b16 v[130:131], v13 offset:256
    ds_read_b128 v[148:151], v6 offset:32
    ds_read_b128 v[152:155], v6 offset:33312
    s_waitcnt vmcnt(6)
    ds_read_b64_tr_b16 v[132:133], v13 offset:1024
    ds_read_b64_tr_b16 v[134:135], v13 offset:1280
    s_mov_b32 s76, s30
    s_mov_b32 s77, s31
    s_mov_b32 s78, 2752
    s_mov_b32 s79, 0x00020000
    s_waitcnt lgkmcnt(4)
    v_mfma_f32_32x32x16_bf16 v[96:111], v[128:131], v[140:143], 0
    s_add_u32 m0, s99, 0
    s_mov_b32 s8, s27
    buffer_load_dwordx4 v11, s[48:51], s8 offen lds
    v_mfma_f32_16x16x32_bf16 v[92:95], v[128:131], v[88:91], 0
    ds_read_b128 v[156:159], v6 offset:64
    ds_read_b128 v[160:163], v6 offset:33344
    v_mfma_f32_32x32x16_bf16 v[112:127], v[128:131], v[144:147], 0
    s_waitcnt vmcnt(6)
    ds_read_b64_tr_b16 v[136:137], v13 offset:2048
    ds_read_b64_tr_b16 v[138:139], v13 offset:2304
    s_waitcnt lgkmcnt(4)
    v_mfma_f32_32x32x16_bf16 v[96:111], v[132:135], v[148:151], v[96:111]
    s_add_u32 m0, s99, 1024
    s_add_u32 s8, s8, s7
    buffer_load_dwordx4 v11, s[48:51], s8 offen lds
    v_mfma_f32_16x16x32_bf16 v[92:95], v[132:135], v[88:91], v[92:95]
    ds_read_b128 v[140:143], v6 offset:96
    ds_read_b128 v[144:147], v6 offset:33376
    v_mfma_f32_32x32x16_bf16 v[112:127], v[132:135], v[152:155], v[112:127]
    s_waitcnt vmcnt(6)
    ds_read_b64_tr_b16 v[128:129], v13 offset:3072
    ds_read_b64_tr_b16 v[130:131], v13 offset:3328
    s_waitcnt lgkmcnt(4)
    v_mfma_f32_32x32x16_bf16 v[96:111], v[136:139], v[156:159], v[96:111]
    s_add_u32 m0, s99, 2048
    s_add_u32 s8, s8, s7
    buffer_load_dwordx4 v11, s[48:51], s8 offen lds
    v_mfma_f32_16x16x32_bf16 v[92:95], v[136:139], v[88:91], v[92:95]
    ds_read_b128 v[148:151], v6 offset:128
    ds_read_b128 v[152:155], v6 offset:33408
    v_mfma_f32_32x32x16_bf16 v[112:127], v[136:139], v[160:163], v[112:127]
    s_waitcnt vmcnt(6)
    ds_read_b64_tr_b16 v[132:133], v13 offset:4096
    ds_read_b64_tr_b16 v[134:135], v13 offset:4352
    s_waitcnt lgkmcnt(4)
    v_mfma_f32_32x32x16_bf16 v[96:111], v[128:131], v[140:143], v[96:111]
    s_add_u32 m0, s99, 3072
    s_add_u32 s8, s8, s7
    buffer_load_dwordx4 v11, s[48:51], s8 offen lds
    v_mfma_f32_16x16x32_bf16 v[92:95], v[128:131], v[88:91], v[92:95]
    ds_read_b128 v[156:159], v6 offset:160
    ds_read_b128 v[160:163], v6 offset:33440
    v_mfma_f32_32x32x16_bf16 v[112:127], v[128:131], v[144:147], v[112:127]
    s_waitcnt vmcnt(6)
    ds_read_b64_tr_b16 v[136:137], v13 offset:5120
    ds_read_b64_tr_b16 v[138:139], v13 offset:5376
    s_waitcnt lgkmcnt(4)
    v_mfma_f32_32x32x16_bf16 v[96:111], v[132:135], v[148:151], v[96:111]
    s_add_u32 m0, s99, 4096
    s_add_u32 s8, s8, s7
    buffer_load_dwordx4 v11, s[48:51], s8 offen lds
    v_mfma_f32_16x16x32_bf16 v[92:95], v[132:135], v[88:91], v[92:95]
    ds_read_b128 v[140:143], v6 offset:192
    ds_read_b128 v[144:147], v6 offset:33472
    v_mfma_f32_32x32x16_bf16 v[112:127], v[132:135], v[152:155], v[112:127]
    s_waitcnt vmcnt(6)
    ds_read_b64_tr_b16 v[128:129], v13 offset:6144
    ds_read_b64_tr_b16 v[130:131], v13 offset:6400
    s_waitcnt lgkmcnt(4)
    v_mfma_f32_32x32x16_bf16 v[96:111], v[136:139], v[156:159], v[96:111]
    s_add_u32 m0, s99, 5120
    s_add_u32 s8, s8, s7
    buffer_load_dwordx4 v11, s[48:51], s8 offen lds
    v_mfma_f32_16x16x32_bf16 v[92:95], v[136:139], v[88:91], v[92:95]
    ds_read_b128 v[148:151], v6 offset:224
    ds_read_b128 v[152:155], v6 offset:33504
    v_mfma_f32_32x32x16_bf16 v[112:127], v[136:139], v[160:163], v[112:127]
    s_waitcnt vmcnt(6)
    ds_read_b64_tr_b16 v[132:133], v13 offset:7168
    ds_read_b64_tr_b16 v[134:135], v13 offset:7424
    s_waitcnt lgkmcnt(4)
    v_mfma_f32_32x32x16_bf16 v[96:111], v[128:131], v[140:143], v[96:111]
    s_add_u32 m0, s99, 6144
    s_add_u32 s8, s8, s7
    buffer_load_dwordx4 v11, s[48:51], s8 offen lds
    v_mfma_f32_16x16x32_bf16 v[92:95], v[128:131], v[88:91], v[92:95]
    ds_read_b128 v[156:159], v7 offset:0
    ds_read_b128 v[160:163], v7 offset:33280
    v_mfma_f32_32x32x16_bf16 v[112:127], v[128:131], v[144:147], v[112:127]
    s_waitcnt vmcnt(6)
    ds_read_b64_tr_b16 v[136:137], v13 offset:0
    ds_read_b64_tr_b16 v[138:139], v13 offset:256
    s_waitcnt lgkmcnt(4)
    v_mfma_f32_32x32x16_bf16 v[96:111], v[132:135], v[148:151], v[96:111]
    s_add_u32 m0, s99, 7168
    s_add_u32 s8, s8, s7
    buffer_load_dwordx4 v11, s[48:51], s8 offen lds
    v_mfma_f32_16x16x32_bf16 v[92:95], v[132:135], v[88:91], v[92:95]
    ds_read_b128 v[140:143], v7 offset:32
    ds_read_b128 v[144:147], v7 offset:33312
    v_mfma_f32_32x32x16_bf16 v[112:127], v[132:135], v[152:155], v[112:127]
    s_waitcnt vmcnt(6)
    ds_read_b64_tr_b16 v[128:129], v13 offset:1024
    ds_read_b64_tr_b16 v[130:131], v13 offset:1280
    s_waitcnt lgkmcnt(4)
    v_mfma_f32_32x32x16_bf16 v[96:111], v[136:139], v[156:159], v[96:111]
    s_add_u32 m0, s99, 0
    s_mov_b32 s8, s38
    buffer_load_dwordx4 v11, s[48:51], s8 offen lds
    v_mfma_f32_16x16x32_bf16 v[92:95], v[136:139], v[88:91], v[92:95]
    ds_read_b128 v[148:151], v7 offset:64
    ds_read_b128 v[152:155], v7 offset:33344
    v_mfma_f32_32x32x16_bf16 v[112:127], v[136:139], v[160:163], v[112:127]
    s_waitcnt vmcnt(6)
    ds_read_b64_tr_b16 v[132:133], v13 offset:2048
    ds_read_b64_tr_b16 v[134:135], v13 offset:2304
    s_waitcnt lgkmcnt(4)
    v_mfma_f32_32x32x16_bf16 v[96:111], v[128:131], v[140:143], v[96:111]
    s_add_u32 m0, s99, 1024
    s_add_u32 s8, s8, s7
    buffer_load_dwordx4 v11, s[48:51], s8 offen lds
    v_mfma_f32_16x16x32_bf16 v[92:95], v[128:131], v[88:91], v[92:95]
    ds_read_b128 v[156:159], v7 offset:96
    ds_read_b128 v[160:163], v7 offset:33376
    v_mfma_f32_32x32x16_bf16 v[112:127], v[128:131], v[144:147], v[112:127]
    s_waitcnt vmcnt(6)
    ds_read_b64_tr_b16 v[136:137], v13 offset:3072
    ds_read_b64_tr_b16 v[138:139], v13 offset:3328
    s_waitcnt lgkmcnt(4)
    v_mfma_f32_32x32x16_bf16 v[96:111], v[132:135], v[148:151], v[96:111]
    s_add_u32 m0, s99, 2048
    s_add_u32 s8, s8, s7
    buffer_load_dwordx4 v11, s[48:51], s8 offen lds
    v_mfma_f32_16x16x32_bf16 v[92:95], v[132:135], v[88:91], v[92:95]
    ds_read_b128 v[140:143], v7 offset:128
    ds_read_b128 v[144:147], v7 offset:33408
    v_mfma_f32_32x32x16_bf16 v[112:127], v[132:135], v[152:155], v[112:127]
    s_waitcnt vmcnt(6)
    ds_read_b64_tr_b16 v[128:129], v13 offset:4096
    ds_read_b64_tr_b16 v[130:131], v13 offset:4352
    s_waitcnt lgkmcnt(4)
    v_mfma_f32_32x32x16_bf16 v[96:111], v[136:139], v[156:159], v[96:111]
    s_add_u32 m0, s99, 3072
    s_add_u32 s8, s8, s7
    buffer_load_dwordx4 v11, s[48:51], s8 offen lds
    v_mfma_f32_16x16x32_bf16 v[92:95], v[136:139], v[88:91], v[92:95]
    ds_read_b128 v[148:151], v7 offset:160
    ds_read_b128 v[152:155], v7 offset:33440
    v_mfma_f32_32x32x16_bf16 v[112:127], v[136:139], v[160:163], v[112:127]
    s_waitcnt vmcnt(6)
    ds_read_b64_tr_b16 v[132:133], v13 offset:5120
    ds_read_b64_tr_b16 v[134:135], v13 offset:5376
    s_waitcnt lgkmcnt(4)
    v_mfma_f32_32x32x16_bf16 v[96:111], v[128:131], v[140:143], v[96:111]
    s_add_u32 m0, s99, 4096
    s_add_u32 s8, s8, s7
    buffer_load_dwordx4 v11, s[48:51], s8 offen lds
    v_mfma_f32_16x16x32_bf16 v[92:95], v[128:131], v[88:91], v[92:95]
    ds_read_b128 v[156:159], v7 offset:192
    ds_read_b128 v[160:163], v7 offset:33472
    v_mfma_f32_32x32x16_bf16 v[112:127], v[128:131], v[144:147], v[112:127]
    s_waitcnt vmcnt(6)
    ds_read_b64_tr_b16 v[136:137], v13 offset:6144
    ds_read_b64_tr_b16 v[138:139], v13 offset:6400
    s_waitcnt lgkmcnt(4)
    v_mfma_f32_32x32x16_bf16 v[96:111], v[132:135], v[148:151], v[96:111]
    s_add_u32 m0, s99, 5120
    s_add_u32 s8, s8, s7
    buffer_load_dwordx4 v11, s[48:51], s8 offen lds
    v_mfma_f32_16x16x32_bf16 v[92:95], v[132:135], v[88:91], v[92:95]
    ds_read_b128 v[140:143], v7 offset:224
    ds_read_b128 v[144:147], v7 offset:33504
    v_mfma_f32_32x32x16_bf16 v[112:127], v[132:135], v[152:155], v[112:127]
    s_waitcnt vmcnt(6)
    ds_read_b64_tr_b16 v[128:129], v13 offset:7168
    ds_read_b64_tr_b16 v[130:131], v13 offset:7424
    s_waitcnt lgkmcnt(4)
    v_mfma_f32_32x32x16_bf16 v[96:111], v[136:139], v[156:159], v[96:111]
    s_add_u32 m0, s99, 6144
    s_add_u32 s8, s8, s7
    buffer_load_dwordx4 v11, s[48:51], s8 offen lds
    v_mfma_f32_16x16x32_bf16 v[92:95], v[136:139], v[88:91], v[92:95]
    ds_read_b128 v[148:151], v8 offset:0
    ds_read_b128 v[152:155], v8 offset:33280
    v_mfma_f32_32x32x16_bf16 v[112:127], v[136:139], v[160:163], v[112:127]
    s_waitcnt vmcnt(6)
    ds_read_b64_tr_b16 v[132:133], v13 offset:0
    ds_read_b64_tr_b16 v[134:135], v13 offset:256
    s_waitcnt lgkmcnt(4)
    v_mfma_f32_32x32x16_bf16 v[96:111], v[128:131], v[140:143], v[96:111]
    s_add_u32 m0, s99, 7168
    s_add_u32 s8, s8, s7
    buffer_load_dwordx4 v11, s[48:51], s8 offen lds
    v_mfma_f32_16x16x32_bf16 v[92:95], v[128:131], v[88:91], v[92:95]
    ds_read_b128 v[156:159], v8 offset:32
    ds_read_b128 v[160:163], v8 offset:33312
    v_mfma_f32_32x32x16_bf16 v[112:127], v[128:131], v[144:147], v[112:127]
    s_waitcnt vmcnt(6)
    ds_read_b64_tr_b16 v[136:137], v13 offset:1024
    ds_read_b64_tr_b16 v[138:139], v13 offset:1280
    s_waitcnt lgkmcnt(4)
    v_mfma_f32_32x32x16_bf16 v[96:111], v[132:135], v[148:151], v[96:111]
    s_add_u32 m0, s99, 0
    s_mov_b32 s8, s39
    buffer_load_dwordx4 v11, s[48:51], s8 offen lds
    v_mfma_f32_16x16x32_bf16 v[92:95], v[132:135], v[88:91], v[92:95]
    ds_read_b128 v[140:143], v8 offset:64
    ds_read_b128 v[144:147], v8 offset:33344
    v_mfma_f32_32x32x16_bf16 v[112:127], v[132:135], v[152:155], v[112:127]
    s_waitcnt vmcnt(6)
    ds_read_b64_tr_b16 v[128:129], v13 offset:2048
    ds_read_b64_tr_b16 v[130:131], v13 offset:2304
    s_lshl_b32 s9, s12, 6
    v_lshl_add_u32 v10, v16, 3, s9
    buffer_load_dwordx2 v[24:25], v10, s[76:79], 0 offen offset:0
    buffer_load_dwordx2 v[26:27], v10, s[76:79], 0 offen offset:16
    buffer_load_dwordx2 v[28:29], v10, s[76:79], 0 offen offset:32
    buffer_load_dwordx2 v[30:31], v10, s[76:79], 0 offen offset:48
    s_waitcnt lgkmcnt(4)
    v_mfma_f32_32x32x16_bf16 v[96:111], v[136:139], v[156:159], v[96:111]
    s_add_u32 m0, s99, 1024
    s_add_u32 s8, s8, s7
    buffer_load_dwordx4 v11, s[48:51], s8 offen lds
    v_mfma_f32_16x16x32_bf16 v[92:95], v[136:139], v[88:91], v[92:95]
    ds_read_b128 v[148:151], v8 offset:96
    ds_read_b128 v[152:155], v8 offset:33376
    v_mfma_f32_32x32x16_bf16 v[112:127], v[136:139], v[160:163], v[112:127]
    s_waitcnt vmcnt(10)
    ds_read_b64_tr_b16 v[132:133], v13 offset:3072
    ds_read_b64_tr_b16 v[134:135], v13 offset:3328
    s_waitcnt lgkmcnt(4)
    v_mfma_f32_32x32x16_bf16 v[96:111], v[128:131], v[140:143], v[96:111]
    s_add_u32 m0, s99, 2048
    s_add_u32 s8, s8, s7
    buffer_load_dwordx4 v11, s[48:51], s8 offen lds
    v_mfma_f32_16x16x32_bf16 v[92:95], v[128:131], v[88:91], v[92:95]
    ds_read_b128 v[156:159], v8 offset:128
    ds_read_b128 v[160:163], v8 offset:33408
    v_mfma_f32_32x32x16_bf16 v[112:127], v[128:131], v[144:147], v[112:127]
    s_waitcnt vmcnt(10)
    ds_read_b64_tr_b16 v[136:137], v13 offset:4096
    ds_read_b64_tr_b16 v[138:139], v13 offset:4352
    s_waitcnt lgkmcnt(4)
    v_mfma_f32_32x32x16_bf16 v[96:111], v[132:135], v[148:151], v[96:111]
    s_add_u32 m0, s99, 3072
    s_add_u32 s8, s8, s7
    buffer_load_dwordx4 v11, s[48:51], s8 offen lds
    v_mfma_f32_16x16x32_bf16 v[92:95], v[132:135], v[88:91], v[92:95]
    ds_read_b128 v[140:143], v8 offset:160
    ds_read_b128 v[144:147], v8 offset:33440
    v_mfma_f32_32x32x16_bf16 v[112:127], v[132:135], v[152:155], v[112:127]
    s_waitcnt vmcnt(10)
    ds_read_b64_tr_b16 v[128:129], v13 offset:5120
    ds_read_b64_tr_b16 v[130:131], v13 offset:5376
    s_waitcnt lgkmcnt(4)
    v_mfma_f32_32x32x16_bf16 v[96:111], v[136:139], v[156:159], v[96:111]
    s_add_u32 m0, s99, 4096
    s_add_u32 s8, s8, s7
    buffer_load_dwordx4 v11, s[48:51], s8 offen lds
    v_mfma_f32_16x16x32_bf16 v[92:95], v[136:139], v[88:91], v[92:95]
    ds_read_b128 v[148:151], v8 offset:192
    ds_read_b128 v[152:155], v8 offset:33472
    v_mfma_f32_32x32x16_bf16 v[112:127], v[136:139], v[160:163], v[112:127]
    s_waitcnt vmcnt(10)
    ds_read_b64_tr_b16 v[132:133], v13 offset:6144
    ds_read_b64_tr_b16 v[134:135], v13 offset:6400
    s_waitcnt lgkmcnt(4)
    v_mfma_f32_32x32x16_bf16 v[96:111], v[128:131], v[140:143], v[96:111]
    s_add_u32 m0, s99, 5120
    s_add_u32 s8, s8, s7
    buffer_load_dwordx4 v11, s[48:51], s8 offen lds
    v_mfma_f32_16x16x32_bf16 v[92:95], v[128:131], v[88:91], v[92:95]
    ds_read_b128 v[156:159], v8 offset:224
    ds_read_b128 v[160:163], v8 offset:33504
    v_mfma_f32_32x32x16_bf16 v[112:127], v[128:131], v[144:147], v[112:127]
    s_waitcnt vmcnt(10)
    ds_read_b64_tr_b16 v[136:137], v13 offset:7168
    ds_read_b64_tr_b16 v[138:139], v13 offset:7424
    s_waitcnt lgkmcnt(4)
    v_mfma_f32_32x32x16_bf16 v[96:111], v[132:135], v[148:151], v[96:111]
    s_add_u32 m0, s99, 6144
    s_add_u32 s8, s8, s7
    buffer_load_dwordx4 v11, s[48:51], s8 offen lds
    v_mfma_f32_16x16x32_bf16 v[92:95], v[132:135], v[88:91], v[92:95]
    ds_read_b128 v[140:143], v9 offset:0
    ds_read_b128 v[144:147], v9 offset:33280
    v_mfma_f32_32x32x16_bf16 v[112:127], v[132:135], v[152:155], v[112:127]
    s_waitcnt vmcnt(10)
    ds_read_b64_tr_b16 v[128:129], v13 offset:0
    ds_read_b64_tr_b16 v[130:131], v13 offset:256
    s_waitcnt lgkmcnt(4)
    v_mfma_f32_32x32x16_bf16 v[96:111], v[136:139], v[156:159], v[96:111]
    s_add_u32 m0, s99, 7168
    s_add_u32 s8, s8, s7
    buffer_load_dwordx4 v11, s[48:51], s8 offen lds
    v_mfma_f32_16x16x32_bf16 v[92:95], v[136:139], v[88:91], v[92:95]
    ds_read_b128 v[148:151], v9 offset:32
    ds_read_b128 v[152:155], v9 offset:33312
    v_mfma_f32_32x32x16_bf16 v[112:127], v[136:139], v[160:163], v[112:127]
    s_waitcnt vmcnt(6)
    ds_read_b64_tr_b16 v[132:133], v13 offset:1024
    ds_read_b64_tr_b16 v[134:135], v13 offset:1280
    s_waitcnt lgkmcnt(4)
    v_mfma_f32_32x32x16_bf16 v[96:111], v[128:131], v[140:143], v[96:111]
    v_mfma_f32_16x16x32_bf16 v[92:95], v[128:131], v[88:91], v[92:95]
    ds_read_b128 v[156:159], v9 offset:64
    ds_read_b128 v[160:163], v9 offset:33344
    v_mfma_f32_32x32x16_bf16 v[112:127], v[128:131], v[144:147], v[112:127]
    s_waitcnt vmcnt(5)
    ds_read_b64_tr_b16 v[136:137], v13 offset:2048
    ds_read_b64_tr_b16 v[138:139], v13 offset:2304
    s_waitcnt lgkmcnt(4)
    v_mfma_f32_32x32x16_bf16 v[96:111], v[132:135], v[148:151], v[96:111]
    v_mfma_f32_16x16x32_bf16 v[92:95], v[132:135], v[88:91], v[92:95]
    ds_read_b128 v[140:143], v9 offset:96
    ds_read_b128 v[144:147], v9 offset:33376
    v_mfma_f32_32x32x16_bf16 v[112:127], v[132:135], v[152:155], v[112:127]
    s_waitcnt vmcnt(4)
    ds_read_b64_tr_b16 v[128:129], v13 offset:3072
    ds_read_b64_tr_b16 v[130:131], v13 offset:3328
    s_waitcnt lgkmcnt(4)
    v_mfma_f32_32x32x16_bf16 v[96:111], v[136:139], v[156:159], v[96:111]
    v_mfma_f32_16x16x32_bf16 v[92:95], v[136:139], v[88:91], v[92:95]
    ds_read_b128 v[148:151], v9 offset:128
    ds_read_b128 v[152:155], v9 offset:33408
    v_mfma_f32_32x32x16_bf16 v[112:127], v[136:139], v[160:163], v[112:127]
    s_waitcnt vmcnt(3)
    ds_read_b64_tr_b16 v[132:133], v13 offset:4096
    ds_read_b64_tr_b16 v[134:135], v13 offset:4352
    s_waitcnt lgkmcnt(4)
    v_mfma_f32_32x32x16_bf16 v[96:111], v[128:131], v[140:143], v[96:111]
    v_mfma_f32_16x16x32_bf16 v[92:95], v[128:131], v[88:91], v[92:95]
    ds_read_b128 v[156:159], v9 offset:160
    ds_read_b128 v[160:163], v9 offset:33440
    v_mfma_f32_32x32x16_bf16 v[112:127], v[128:131], v[144:147], v[112:127]
    s_waitcnt vmcnt(2)
    ds_read_b64_tr_b16 v[136:137], v13 offset:5120
    ds_read_b64_tr_b16 v[138:139], v13 offset:5376
    s_waitcnt lgkmcnt(4)
    v_mfma_f32_32x32x16_bf16 v[96:111], v[132:135], v[148:151], v[96:111]
    v_mfma_f32_16x16x32_bf16 v[92:95], v[132:135], v[88:91], v[92:95]
    ds_read_b128 v[140:143], v9 offset:192
    ds_read_b128 v[144:147], v9 offset:33472
    v_mfma_f32_32x32x16_bf16 v[112:127], v[132:135], v[152:155], v[112:127]
    s_waitcnt vmcnt(1)
    ds_read_b64_tr_b16 v[128:129], v13 offset:6144
    ds_read_b64_tr_b16 v[130:131], v13 offset:6400
    v_lshlrev_b32 v10, 2, v18
    v_add_u32 v10, 159744, v10
    ds_read_b32 v20, v10 offset:0
    ds_read_b32 v64, v10 offset:256
    ds_read_b32 v22, v10 offset:128
    ds_read_b32 v66, v10 offset:384
    s_waitcnt lgkmcnt(8)
    v_mfma_f32_32x32x16_bf16 v[96:111], v[136:139], v[156:159], v[96:111]
    v_mfma_f32_16x16x32_bf16 v[92:95], v[136:139], v[88:91], v[92:95]
    ds_read_b128 v[148:151], v9 offset:224
    ds_read_b128 v[152:155], v9 offset:33504
    v_mfma_f32_32x32x16_bf16 v[112:127], v[136:139], v[160:163], v[112:127]
    s_waitcnt vmcnt(0)
    ds_read_b64_tr_b16 v[132:133], v13 offset:7168
    ds_read_b64_tr_b16 v[134:135], v13 offset:7424
    s_waitcnt lgkmcnt(8)
    v_mfma_f32_32x32x16_bf16 v[96:111], v[128:131], v[140:143], v[96:111]
    v_mfma_f32_16x16x32_bf16 v[92:95], v[128:131], v[88:91], v[92:95]
    v_mfma_f32_32x32x16_bf16 v[112:127], v[128:131], v[144:147], v[112:127]
    s_waitcnt lgkmcnt(0)
    v_mfma_f32_32x32x16_bf16 v[96:111], v[132:135], v[148:151], v[96:111]
    v_mfma_f32_16x16x32_bf16 v[92:95], v[132:135], v[88:91], v[92:95]
    v_mfma_f32_32x32x16_bf16 v[112:127], v[132:135], v[152:155], v[112:127]
    s_lshl_b32 s11, s3, 7
    s_add_u32 s11, s11, 160768
    v_lshlrev_b32 v10, 6, v5
    v_lshl_add_u32 v10, v4, 4, v10
    v_add_u32 v10, s11, v10
    v_cmp_gt_u32 vcc, 2, v5
    s_nop 0
    s_and_saveexec_b64 s[26:27], vcc
    ds_write_b128 v10, v[92:95]
    s_mov_b64 exec, s[26:27]
    v_lshl_add_u32 v10, v16, 4, s11
    ds_read_b128 v[72:75], v10 offset:0
    ds_read_b128 v[76:79], v10 offset:32
    ds_read_b128 v[80:83], v10 offset:64
    ds_read_b128 v[84:87], v10 offset:96
    s_cmp_ge_u32 s3, 2
    s_cbranch_scc1 L_epffn_6
    v_lshlrev_b32 v19, 5, v1
    s_mov_b32 s21, 4096
    s_mov_b32 s42, 0x4000
L_pkv_8:
    buffer_load_dwordx4 v[48:51], v19, s[56:59], s21 offen sc1
    buffer_load_dwordx4 v[52:55], v19, s[56:59], s21 offen offset:16 sc1
    s_waitcnt vmcnt(0)
    v_xor_b32 v48, s6, v48
    v_xor_b32 v50, s6, v50
    v_xor_b32 v52, s6, v52
    v_xor_b32 v54, s6, v54
    v_or3_b32 v48, v48, v50, v52
    v_or_b32 v48, v48, v54
    v_cmp_ne_u32 vcc, 0, v48
    s_nop 4
    s_cbranch_vccz L_pkvok_9
    s_sleep 4
    s_sub_u32 s42, s42, 1
    s_cmp_lg_u32 s42, 0
    s_cbranch_scc1 L_pkv_8
L_pkvok_9:
    s_lshl_b32 s9, s3, 15
    s_add_u32 s10, s9, 131072
    s_add_u32 s9, s9, 65536
    v_add_u32 v56, 0x1000, v2
    buffer_load_dwordx4 v[192:195], v2, s[56:59], s9 offen offset:0 sc1
    buffer_load_dwordx4 v[224:227], v2, s[56:59], s10 offen offset:0 sc1
    buffer_load_dwordx4 v[196:199], v2, s[56:59], s9 offen offset:1024 sc1
    buffer_load_dwordx4 v[228:231], v2, s[56:59], s10 offen offset:1024 sc1
    buffer_load_dwordx4 v[200:203], v2, s[56:59], s9 offen offset:2048 sc1
    buffer_load_dwordx4 v[232:235], v2, s[56:59], s10 offen offset:2048 sc1
    buffer_load_dwordx4 v[204:207], v2, s[56:59], s9 offen offset:3072 sc1
    buffer_load_dwordx4 v[236:239], v2, s[56:59], s10 offen offset:3072 sc1
    buffer_load_dwordx4 v[208:211], v56, s[56:59], s9 offen offset:0 sc1
    buffer_load_dwordx4 v[240:243], v56, s[56:59], s10 offen offset:0 sc1
    buffer_load_dwordx4 v[212:215], v56, s[56:59], s9 offen offset:1024 sc1
    buffer_load_dwordx4 v[244:247], v56, s[56:59], s10 offen offset:1024 sc1
    buffer_load_dwordx4 v[216:219], v56, s[56:59], s9 offen offset:2048 sc1
    buffer_load_dwordx4 v[248:251], v56, s[56:59], s10 offen offset:2048 sc1
    buffer_load_dwordx4 v[220:223], v56, s[56:59], s9 offen offset:3072 sc1
    buffer_load_dwordx4 v[252:255], v56, s[56:59], s10 offen offset:3072 sc1
    v_mul_f32 v20, 0x3eb8aa3b, v20
    v_mul_f32 v22, 0x3eb8aa3b, v22
    s_lshl_b32 s9, s3, 12
    s_add_u32 s9, s9, 135168
    v_add_u32 v59, s9, v2
    s_waitcnt lgkmcnt(3)
    v_pk_fma_f32 v[96:97], v[72:73], v[64:65], v[96:97] op_sel_hi:[1,0,1]
    v_pk_fma_f32 v[98:99], v[74:75], v[64:65], v[98:99] op_sel_hi:[1,0,1]
    s_waitcnt lgkmcnt(2)
    v_pk_fma_f32 v[100:101], v[76:77], v[64:65], v[100:101] op_sel_hi:[1,0,1]
    v_pk_fma_f32 v[102:103], v[78:79], v[64:65], v[102:103] op_sel_hi:[1,0,1]
    s_waitcnt lgkmcnt(1)
    v_pk_fma_f32 v[104:105], v[80:81], v[64:65], v[104:105] op_sel_hi:[1,0,1]
    v_pk_fma_f32 v[106:107], v[82:83], v[64:65], v[106:107] op_sel_hi:[1,0,1]
    s_waitcnt lgkmcnt(0)
    v_pk_fma_f32 v[108:109], v[84:85], v[64:65], v[108:109] op_sel_hi:[1,0,1]
    v_pk_fma_f32 v[110:111], v[86:87], v[64:65], v[110:111] op_sel_hi:[1,0,1]
    v_pk_mul_f32 v[96:97], v[96:97], v[20:21] op_sel_hi:[1,0]
    v_pk_mul_f32 v[98:99], v[98:99], v[20:21] op_sel_hi:[1,0]
    v_pk_mul_f32 v[100:101], v[100:101], v[20:21] op_sel_hi:[1,0]
    v_pk_mul_f32 v[102:103], v[102:103], v[20:21] op_sel_hi:[1,0]
    v_pk_mul_f32 v[104:105], v[104:105], v[20:21] op_sel_hi:[1,0]
    v_pk_mul_f32 v[106:107], v[106:107], v[20:21] op_sel_hi:[1,0]
    v_pk_mul_f32 v[108:109], v[108:109], v[20:21] op_sel_hi:[1,0]
    v_pk_mul_f32 v[110:111], v[110:111], v[20:21] op_sel_hi:[1,0]
    v_cvt_pk_bf16_f32 v32, v96, v97
    v_cvt_pk_bf16_f32 v33, v98, v99
    v_cvt_pk_bf16_f32 v34, v100, v101
    v_cvt_pk_bf16_f32 v35, v102, v103
    v_cvt_pk_bf16_f32 v36, v104, v105
    v_cvt_pk_bf16_f32 v37, v106, v107
    v_cvt_pk_bf16_f32 v38, v108, v109
    v_cvt_pk_bf16_f32 v39, v110, v111
    ds_write_b128 v59, v[32:35] offset:0
    ds_write_b128 v59, v[36:39] offset:1024
    v_pk_fma_f32 v[112:113], v[72:73], v[66:67], v[112:113] op_sel_hi:[1,0,1]
    v_pk_fma_f32 v[114:115], v[74:75], v[66:67], v[114:115] op_sel_hi:[1,0,1]
    v_pk_fma_f32 v[116:117], v[76:77], v[66:67], v[116:117] op_sel_hi:[1,0,1]
    v_pk_fma_f32 v[118:119], v[78:79], v[66:67], v[118:119] op_sel_hi:[1,0,1]
    v_pk_fma_f32 v[120:121], v[80:81], v[66:67], v[120:121] op_sel_hi:[1,0,1]
    v_pk_fma_f32 v[122:123], v[82:83], v[66:67], v[122:123] op_sel_hi:[1,0,1]
    v_pk_fma_f32 v[124:125], v[84:85], v[66:67], v[124:125] op_sel_hi:[1,0,1]
    v_pk_fma_f32 v[126:127], v[86:87], v[66:67], v[126:127] op_sel_hi:[1,0,1]
    v_pk_mul_f32 v[112:113], v[112:113], v[22:23] op_sel_hi:[1,0]
    v_pk_mul_f32 v[114:115], v[114:115], v[22:23] op_sel_hi:[1,0]
    v_pk_mul_f32 v[116:117], v[116:117], v[22:23] op_sel_hi:[1,0]
    v_pk_mul_f32 v[118:119], v[118:119], v[22:23] op_sel_hi:[1,0]
    v_pk_mul_f32 v[120:121], v[120:121], v[22:23] op_sel_hi:[1,0]
    v_pk_mul_f32 v[122:123], v[122:123], v[22:23] op_sel_hi:[1,0]
    v_pk_mul_f32 v[124:125], v[124:125], v[22:23] op_sel_hi:[1,0]
    v_pk_mul_f32 v[126:127], v[126:127], v[22:23] op_sel_hi:[1,0]
    v_cvt_pk_bf16_f32 v40, v112, v113
    v_cvt_pk_bf16_f32 v41, v114, v115
    v_cvt_pk_bf16_f32 v42, v116, v117
    v_cvt_pk_bf16_f32 v43, v118, v119
    v_cvt_pk_bf16_f32 v44, v120, v121
    v_cvt_pk_bf16_f32 v45, v122, v123
    v_cvt_pk_bf16_f32 v46, v124, v125
    v_cvt_pk_bf16_f32 v47, v126, v127
    ds_write_b128 v59, v[40:43] offset:2048
    ds_write_b128 v59, v[44:47] offset:3072
    v_max3_f32 v61, v49, v51, v53
    v_max_f32 v61, v61, v55
    s_nop 1
    v_max_f32_dpp v60, v61, v61 row_ror:8 row_mask:0xf bank_mask:0xf
    v_mov_b32 v61, v60
    s_nop 1
    v_max_f32_dpp v60, v61, v61 row_ror:4 row_mask:0xf bank_mask:0xf
    v_mov_b32 v61, v60
    s_nop 1
    v_max_f32_dpp v60, v61, v61 row_ror:2 row_mask:0xf bank_mask:0xf
    v_mov_b32 v61, v60
    s_nop 1
    v_max_f32_dpp v60, v61, v61 row_ror:1 row_mask:0xf bank_mask:0xf
    v_mov_b32 v61, v60
    s_nop 1
    v_permlane16_swap_b32 v60, v61
    v_max_f32 v61, v60, v61
    v_mov_b32 v60, v61
    s_nop 1
    v_permlane32_swap_b32 v60, v61
    v_max_f32 v61, v60, v61
    s_lshl_b32 s9, s3, 10
    s_add_u32 s9, s9, 161792
    v_lshl_add_u32 v60, v1, 2, s9
    v_dot2_f32_bf16 v48, v32, v32, 0
    v_dot2_f32_bf16 v48, v33, v33, v48
    v_dot2_f32_bf16 v48, v34, v34, v48
    v_dot2_f32_bf16 v48, v35, v35, v48
    v_dot2_f32_bf16 v50, v36, v36, 0
    v_dot2_f32_bf16 v50, v37, v37, v50
    v_dot2_f32_bf16 v50, v38, v38, v50
    v_dot2_f32_bf16 v50, v39, v39, v50
    v_dot2_f32_bf16 v52, v40, v40, 0
    v_dot2_f32_bf16 v52, v41, v41, v52
    v_dot2_f32_bf16 v52, v42, v42, v52
    v_dot2_f32_bf16 v52, v43, v43, v52
    v_dot2_f32_bf16 v54, v44, v44, 0
    v_dot2_f32_bf16 v54, v45, v45, v54
    v_dot2_f32_bf16 v54, v46, v46, v54
    v_dot2_f32_bf16 v54, v47, v47, v54
    v_mov_b32 v49, v48
    s_nop 1
    v_permlane32_swap_b32 v48, v49
    v_add_f32 v48, v48, v49
    v_mul_f32 v48, v48, v61
    v_sqrt_f32 v48, v48
    s_nop 0
    ds_write_b32 v60, v48 offset:0
    v_mov_b32 v51, v50
    s_nop 1
    v_permlane32_swap_b32 v50, v51
    v_add_f32 v50, v50, v51
    v_mul_f32 v50, v50, v61
    v_sqrt_f32 v50, v50
    s_nop 0
    ds_write_b32 v60, v50 offset:256
    v_mov_b32 v53, v52
    s_nop 1
    v_permlane32_swap_b32 v52, v53
    v_add_f32 v52, v52, v53
    v_mul_f32 v52, v52, v61
    v_sqrt_f32 v52, v52
    s_nop 0
    ds_write_b32 v60, v52 offset:512
    v_mov_b32 v55, v54
    s_nop 1
    v_permlane32_swap_b32 v54, v55
    v_add_f32 v54, v54, v55
    v_mul_f32 v54, v54, v61
    v_sqrt_f32 v54, v54
    s_nop 0
    ds_write_b32 v60, v54 offset:768
    s_lshl_b32 s11, s3, 13
    s_add_u32 s11, s11, 143360
    v_add_u32 v56, s11, v2
    v_mul_u32_u24 v57, 272, v4
    v_lshl_add_u32 v57, v5, 4, v57
    v_add_u32 v57, s99, v57
    v_mul_u32_u24 v58, 272, v18
    v_add_u32 v58, s99, v58
    v_mov_b32 v64, s13
    v_mov_b32 v65, s13
    v_mov_b32 v66, s13
    v_mov_b32 v67, s13
    ds_write_b128 v58, v[64:67] offset:256
    s_waitcnt vmcnt(15)
    ds_write_b128 v56, v[192:195] offset:0
    s_waitcnt vmcnt(14)
    ds_write_b128 v57, v[224:227] offset:0
    s_waitcnt vmcnt(13)
    ds_write_b128 v56, v[196:199] offset:1024
    s_waitcnt vmcnt(12)
    ds_write_b128 v57, v[228:231] offset:1088
    s_waitcnt vmcnt(11)
    ds_write_b128 v56, v[200:203] offset:2048
    s_waitcnt vmcnt(10)
    ds_write_b128 v57, v[232:235] offset:2176
    s_waitcnt vmcnt(9)
    ds_write_b128 v56, v[204:207] offset:3072
    s_waitcnt vmcnt(8)
    ds_write_b128 v57, v[236:239] offset:3264
    s_waitcnt vmcnt(7)
    ds_write_b128 v56, v[208:211] offset:4096
    s_waitcnt vmcnt(6)
    ds_write_b128 v57, v[240:243] offset:4352
    s_waitcnt vmcnt(5)
    ds_write_b128 v56, v[212:215] offset:5120
    s_waitcnt vmcnt(4)
    ds_write_b128 v57, v[244:247] offset:5440
    s_waitcnt vmcnt(3)
    ds_write_b128 v56, v[216:219] offset:6144
    s_waitcnt vmcnt(2)
    ds_write_b128 v57, v[248:251] offset:6528
    s_waitcnt vmcnt(1)
    ds_write_b128 v56, v[220:223] offset:7168
    s_waitcnt vmcnt(0)
    ds_write_b128 v57, v[252:255] offset:7616
    s_branch L_epdone_7
L_epffn_6:
    s_mov_b32 s90, 0xbdd2d3e8
    s_mov_b32 s91, 0xbdd2d3e8
    v_lshlrev_b32 v32, 16, v24
    v_and_b32 v33, 0xffff0000, v24
    v_lshlrev_b32 v34, 16, v25
    v_and_b32 v35, 0xffff0000, v25
    v_lshlrev_b32 v36, 16, v26
    v_and_b32 v37, 0xffff0000, v26
    v_lshlrev_b32 v38, 16, v27
    v_and_b32 v39, 0xffff0000, v27
    v_lshlrev_b32 v40, 16, v28
    v_and_b32 v41, 0xffff0000, v28
    v_lshlrev_b32 v42, 16, v29
    v_and_b32 v43, 0xffff0000, v29
    v_lshlrev_b32 v44, 16, v30
    v_and_b32 v45, 0xffff0000, v30
    v_lshlrev_b32 v46, 16, v31
    v_and_b32 v47, 0xffff0000, v31
    v_mov_b32 v48, 0xc0135761
    v_mov_b32 v49, 0xc0135761
    s_lshl_b32 s9, s12, 12
    s_waitcnt lgkmcnt(3)
    v_pk_fma_f32 v[96:97], v[72:73], v[64:65], v[96:97] op_sel_hi:[1,0,1]
    v_pk_fma_f32 v[98:99], v[74:75], v[64:65], v[98:99] op_sel_hi:[1,0,1]
    s_waitcnt lgkmcnt(2)
    v_pk_fma_f32 v[100:101], v[76:77], v[64:65], v[100:101] op_sel_hi:[1,0,1]
    v_pk_fma_f32 v[102:103], v[78:79], v[64:65], v[102:103] op_sel_hi:[1,0,1]
    v_pk_fma_f32 v[96:97], v[96:97], v[20:21], v[32:33] op_sel_hi:[1,0,1]
    v_pk_fma_f32 v[98:99], v[98:99], v[20:21], v[34:35] op_sel_hi:[1,0,1]
    v_pk_fma_f32 v[100:101], v[100:101], v[20:21], v[36:37] op_sel_hi:[1,0,1]
    v_pk_fma_f32 v[102:103], v[102:103], v[20:21], v[38:39] op_sel_hi:[1,0,1]
    v_pk_mul_f32 v[52:53], v[96:97], v[96:97]
    v_pk_mul_f32 v[54:55], v[98:99], v[98:99]
    v_pk_mul_f32 v[56:57], v[100:101], v[100:101]
    v_pk_mul_f32 v[58:59], v[102:103], v[102:103]
    v_pk_fma_f32 v[52:53], v[52:53], s[90:91], v[48:49]
    v_pk_fma_f32 v[54:55], v[54:55], s[90:91], v[48:49]
    v_pk_fma_f32 v[56:57], v[56:57], s[90:91], v[48:49]
    v_pk_fma_f32 v[58:59], v[58:59], s[90:91], v[48:49]
    v_pk_mul_f32 v[52:53], v[52:53], v[96:97]
    v_pk_mul_f32 v[54:55], v[54:55], v[98:99]
    v_pk_mul_f32 v[56:57], v[56:57], v[100:101]
    v_pk_mul_f32 v[58:59], v[58:59], v[102:103]
    v_exp_f32 v52, v52
    v_exp_f32 v53, v53
    v_exp_f32 v54, v54
    v_exp_f32 v55, v55
    v_exp_f32 v56, v56
    v_exp_f32 v57, v57
    v_exp_f32 v58, v58
    v_exp_f32 v59, v59
    v_pk_add_f32 v[52:53], v[52:53], 1.0 op_sel_hi:[1,0]
    v_pk_add_f32 v[54:55], v[54:55], 1.0 op_sel_hi:[1,0]
    v_pk_add_f32 v[56:57], v[56:57], 1.0 op_sel_hi:[1,0]
    v_pk_add_f32 v[58:59], v[58:59], 1.0 op_sel_hi:[1,0]
    v_rcp_f32 v52, v52
    v_rcp_f32 v53, v53
    v_rcp_f32 v54, v54
    v_rcp_f32 v55, v55
    v_rcp_f32 v56, v56
    v_rcp_f32 v57, v57
    v_rcp_f32 v58, v58
    v_rcp_f32 v59, v59
    v_pk_mul_f32 v[52:53], v[52:53], v[96:97]
    v_pk_mul_f32 v[54:55], v[54:55], v[98:99]
    v_pk_mul_f32 v[56:57], v[56:57], v[100:101]
    v_pk_mul_f32 v[58:59], v[58:59], v[102:103]
    v_cvt_pk_bf16_f32 v128, v52, v53
    v_cvt_pk_bf16_f32 v129, v54, v55
    v_cvt_pk_bf16_f32 v130, v56, v57
    v_cvt_pk_bf16_f32 v131, v58, v59
    buffer_store_dwordx4 v[128:131], v2, s[60:63], s9 offen offset:0 sc1
    s_waitcnt lgkmcnt(1)
    v_pk_fma_f32 v[104:105], v[80:81], v[64:65], v[104:105] op_sel_hi:[1,0,1]
    v_pk_fma_f32 v[106:107], v[82:83], v[64:65], v[106:107] op_sel_hi:[1,0,1]
    s_waitcnt lgkmcnt(0)
    v_pk_fma_f32 v[108:109], v[84:85], v[64:65], v[108:109] op_sel_hi:[1,0,1]
    v_pk_fma_f32 v[110:111], v[86:87], v[64:65], v[110:111] op_sel_hi:[1,0,1]
    v_pk_fma_f32 v[104:105], v[104:105], v[20:21], v[40:41] op_sel_hi:[1,0,1]
    v_pk_fma_f32 v[106:107], v[106:107], v[20:21], v[42:43] op_sel_hi:[1,0,1]
    v_pk_fma_f32 v[108:109], v[108:109], v[20:21], v[44:45] op_sel_hi:[1,0,1]
    v_pk_fma_f32 v[110:111], v[110:111], v[20:21], v[46:47] op_sel_hi:[1,0,1]
    v_pk_mul_f32 v[52:53], v[104:105], v[104:105]
    v_pk_mul_f32 v[54:55], v[106:107], v[106:107]
    v_pk_mul_f32 v[56:57], v[108:109], v[108:109]
    v_pk_mul_f32 v[58:59], v[110:111], v[110:111]
    v_pk_fma_f32 v[52:53], v[52:53], s[90:91], v[48:49]
    v_pk_fma_f32 v[54:55], v[54:55], s[90:91], v[48:49]
    v_pk_fma_f32 v[56:57], v[56:57], s[90:91], v[48:49]
    v_pk_fma_f32 v[58:59], v[58:59], s[90:91], v[48:49]
    v_pk_mul_f32 v[52:53], v[52:53], v[104:105]
    v_pk_mul_f32 v[54:55], v[54:55], v[106:107]
    v_pk_mul_f32 v[56:57], v[56:57], v[108:109]
    v_pk_mul_f32 v[58:59], v[58:59], v[110:111]
    v_exp_f32 v52, v52
    v_exp_f32 v53, v53
    v_exp_f32 v54, v54
    v_exp_f32 v55, v55
    v_exp_f32 v56, v56
    v_exp_f32 v57, v57
    v_exp_f32 v58, v58
    v_exp_f32 v59, v59
    v_pk_add_f32 v[52:53], v[52:53], 1.0 op_sel_hi:[1,0]
    v_pk_add_f32 v[54:55], v[54:55], 1.0 op_sel_hi:[1,0]
    v_pk_add_f32 v[56:57], v[56:57], 1.0 op_sel_hi:[1,0]
    v_pk_add_f32 v[58:59], v[58:59], 1.0 op_sel_hi:[1,0]
    v_rcp_f32 v52, v52
    v_rcp_f32 v53, v53
    v_rcp_f32 v54, v54
    v_rcp_f32 v55, v55
    v_rcp_f32 v56, v56
    v_rcp_f32 v57, v57
    v_rcp_f32 v58, v58
    v_rcp_f32 v59, v59
    v_pk_mul_f32 v[52:53], v[52:53], v[104:105]
    v_pk_mul_f32 v[54:55], v[54:55], v[106:107]
    v_pk_mul_f32 v[56:57], v[56:57], v[108:109]
    v_pk_mul_f32 v[58:59], v[58:59], v[110:111]
    v_cvt_pk_bf16_f32 v132, v52, v53
    v_cvt_pk_bf16_f32 v133, v54, v55
    v_cvt_pk_bf16_f32 v134, v56, v57
    v_cvt_pk_bf16_f32 v135, v58, v59
    buffer_store_dwordx4 v[132:135], v2, s[60:63], s9 offen offset:2048 sc1
    v_pk_fma_f32 v[112:113], v[72:73], v[66:67], v[112:113] op_sel_hi:[1,0,1]
    v_pk_fma_f32 v[114:115], v[74:75], v[66:67], v[114:115] op_sel_hi:[1,0,1]
    v_pk_fma_f32 v[116:117], v[76:77], v[66:67], v[116:117] op_sel_hi:[1,0,1]
    v_pk_fma_f32 v[118:119], v[78:79], v[66:67], v[118:119] op_sel_hi:[1,0,1]
    v_pk_fma_f32 v[112:113], v[112:113], v[22:23], v[32:33] op_sel_hi:[1,0,1]
    v_pk_fma_f32 v[114:115], v[114:115], v[22:23], v[34:35] op_sel_hi:[1,0,1]
    v_pk_fma_f32 v[116:117], v[116:117], v[22:23], v[36:37] op_sel_hi:[1,0,1]
    v_pk_fma_f32 v[118:119], v[118:119], v[22:23], v[38:39] op_sel_hi:[1,0,1]
    v_pk_mul_f32 v[52:53], v[112:113], v[112:113]
    v_pk_mul_f32 v[54:55], v[114:115], v[114:115]
    v_pk_mul_f32 v[56:57], v[116:117], v[116:117]
    v_pk_mul_f32 v[58:59], v[118:119], v[118:119]
    v_pk_fma_f32 v[52:53], v[52:53], s[90:91], v[48:49]
    v_pk_fma_f32 v[54:55], v[54:55], s[90:91], v[48:49]
    v_pk_fma_f32 v[56:57], v[56:57], s[90:91], v[48:49]
    v_pk_fma_f32 v[58:59], v[58:59], s[90:91], v[48:49]
    v_pk_mul_f32 v[52:53], v[52:53], v[112:113]
    v_pk_mul_f32 v[54:55], v[54:55], v[114:115]
    v_pk_mul_f32 v[56:57], v[56:57], v[116:117]
    v_pk_mul_f32 v[58:59], v[58:59], v[118:119]
    v_exp_f32 v52, v52
    v_exp_f32 v53, v53
    v_exp_f32 v54, v54
    v_exp_f32 v55, v55
    v_exp_f32 v56, v56
    v_exp_f32 v57, v57
    v_exp_f32 v58, v58
    v_exp_f32 v59, v59
    v_pk_add_f32 v[52:53], v[52:53], 1.0 op_sel_hi:[1,0]
    v_pk_add_f32 v[54:55], v[54:55], 1.0 op_sel_hi:[1,0]
    v_pk_add_f32 v[56:57], v[56:57], 1.0 op_sel_hi:[1,0]
    v_pk_add_f32 v[58:59], v[58:59], 1.0 op_sel_hi:[1,0]
    v_rcp_f32 v52, v52
    v_rcp_f32 v53, v53
    v_rcp_f32 v54, v54
    v_rcp_f32 v55, v55
    v_rcp_f32 v56, v56
    v_rcp_f32 v57, v57
    v_rcp_f32 v58, v58
    v_rcp_f32 v59, v59
    v_pk_mul_f32 v[52:53], v[52:53], v[112:113]
    v_pk_mul_f32 v[54:55], v[54:55], v[114:115]
    v_pk_mul_f32 v[56:57], v[56:57], v[116:117]
    v_pk_mul_f32 v[58:59], v[58:59], v[118:119]
    v_cvt_pk_bf16_f32 v136, v52, v53
    v_cvt_pk_bf16_f32 v137, v54, v55
    v_cvt_pk_bf16_f32 v138, v56, v57
    v_cvt_pk_bf16_f32 v139, v58, v59
    buffer_store_dwordx4 v[136:139], v2, s[60:63], s9 offen offset:1024 sc1
    v_pk_fma_f32 v[120:121], v[80:81], v[66:67], v[120:121] op_sel_hi:[1,0,1]
    v_pk_fma_f32 v[122:123], v[82:83], v[66:67], v[122:123] op_sel_hi:[1,0,1]
    v_pk_fma_f32 v[124:125], v[84:85], v[66:67], v[124:125] op_sel_hi:[1,0,1]
    v_pk_fma_f32 v[126:127], v[86:87], v[66:67], v[126:127] op_sel_hi:[1,0,1]
    v_pk_fma_f32 v[120:121], v[120:121], v[22:23], v[40:41] op_sel_hi:[1,0,1]
    v_pk_fma_f32 v[122:123], v[122:123], v[22:23], v[42:43] op_sel_hi:[1,0,1]
    v_pk_fma_f32 v[124:125], v[124:125], v[22:23], v[44:45] op_sel_hi:[1,0,1]
    v_pk_fma_f32 v[126:127], v[126:127], v[22:23], v[46:47] op_sel_hi:[1,0,1]
    v_pk_mul_f32 v[52:53], v[120:121], v[120:121]
    v_pk_mul_f32 v[54:55], v[122:123], v[122:123]
    v_pk_mul_f32 v[56:57], v[124:125], v[124:125]
    v_pk_mul_f32 v[58:59], v[126:127], v[126:127]
    v_pk_fma_f32 v[52:53], v[52:53], s[90:91], v[48:49]
    v_pk_fma_f32 v[54:55], v[54:55], s[90:91], v[48:49]
    v_pk_fma_f32 v[56:57], v[56:57], s[90:91], v[48:49]
    v_pk_fma_f32 v[58:59], v[58:59], s[90:91], v[48:49]
    v_pk_mul_f32 v[52:53], v[52:53], v[120:121]
    v_pk_mul_f32 v[54:55], v[54:55], v[122:123]
    v_pk_mul_f32 v[56:57], v[56:57], v[124:125]
    v_pk_mul_f32 v[58:59], v[58:59], v[126:127]
    v_exp_f32 v52, v52
    v_exp_f32 v53, v53
    v_exp_f32 v54, v54
    v_exp_f32 v55, v55
    v_exp_f32 v56, v56
    v_exp_f32 v57, v57
    v_exp_f32 v58, v58
    v_exp_f32 v59, v59
    v_pk_add_f32 v[52:53], v[52:53], 1.0 op_sel_hi:[1,0]
    v_pk_add_f32 v[54:55], v[54:55], 1.0 op_sel_hi:[1,0]
    v_pk_add_f32 v[56:57], v[56:57], 1.0 op_sel_hi:[1,0]
    v_pk_add_f32 v[58:59], v[58:59], 1.0 op_sel_hi:[1,0]
    v_rcp_f32 v52, v52
    v_rcp_f32 v53, v53
    v_rcp_f32 v54, v54
    v_rcp_f32 v55, v55
    v_rcp_f32 v56, v56
    v_rcp_f32 v57, v57
    v_rcp_f32 v58, v58
    v_rcp_f32 v59, v59
    v_pk_mul_f32 v[52:53], v[52:53], v[120:121]
    v_pk_mul_f32 v[54:55], v[54:55], v[122:123]
    v_pk_mul_f32 v[56:57], v[56:57], v[124:125]
    v_pk_mul_f32 v[58:59], v[58:59], v[126:127]
    v_cvt_pk_bf16_f32 v140, v52, v53
    v_cvt_pk_bf16_f32 v141, v54, v55
    v_cvt_pk_bf16_f32 v142, v56, v57
    v_cvt_pk_bf16_f32 v143, v58, v59
    buffer_store_dwordx4 v[140:143], v2, s[60:63], s9 offen offset:3072 sc1
L_epdone_7:
    s_nop 1
L_skip2_5:
    s_add_u32 s20, s5, s4
    s_and_b32 s20, s20, 7
    s_xor_b32 s20, s20, s3
    s_lshl_b32 s9, s20, 10
    s_add_u32 s23, s9, 139264
    s_add_u32 s22, s9, 73728
    v_add_u32 v191, 0x8000, v2
    s_lshl_b32 s11, s20, 10
    v_add_u32 v184, s11, v2
    v_add_u32 v185, 0x8000, v184
    s_mul_i32 s11, s20, 1088
    s_add_u32 s11, s11, 65536
    v_mul_u32_u24 v25, 272, v4
    v_lshl_add_u32 v25, v5, 4, v25
    v_add_u32 v186, s11, v25
    v_add_u32 v187, 8704, v186
    s_mul_i32 s11, s3, 4352
    s_add_u32 s11, s11, 82944
    v_mul_u32_u24 v183, 272, v5
    v_add_u32 v183, s11, v183
    v_mov_b32 v176, s13
    v_mov_b32 v177, s13
    v_mov_b32 v178, s13
    v_mov_b32 v179, s13
    v_mov_b32 v188, v17
    v_mov_b32 v189, v16
    v_mov_b32 v190, v18
    s_and_b32 s11, s3, 3
    s_lshl_b32 s9, s11, 11
    s_add_u32 s9, s9, 135168
    v_add_u32 v165, s9, v2
    s_lshl_b32 s9, s11, 9
    s_add_u32 s9, s9, 161792
    v_lshl_add_u32 v166, v1, 2, s9
    s_lshl_b32 s11, s96, 15
    v_add_u32 v24, s11, v2
    s_lshl_b32 s11, s96, 13
    s_add_u32 s11, s11, 143360
    v_add_u32 v29, s11, v2
    s_mul_i32 s11, s96, 8704
    s_add_u32 s11, s11, 65536
    v_min_u32 v25, 16, v18
    v_lshlrev_b32 v25, 4, v25
    v_mul_u32_u24 v167, 272, v16
    v_add3_u32 v25, v25, v167, s11
    v_and_b32 v167, 27, v18
    v_cmp_lt_u32 s[20:21], 16, v167
    v_mov_b32 v167, 0x80000
    s_nop 0
    v_cndmask_b32 v25, v25, v167, s[20:21]
    s_waitcnt lgkmcnt(0)
    s_barrier
    ds_read_b32 v180, v166
    ds_read_b32 v182, v166 offset:256
    ds_read_b128 v[4:7], v165
    ds_read_b128 v[12:15], v29 offset:0
    ds_read_b128 v[8:11], v165 offset:1024
    ds_write_b128 v183, v[176:179] offset:256
    s_waitcnt lgkmcnt(5)
    v_sub_f32 v32, 0, v180
    v_sub_f32 v33, 0, v180
    v_sub_f32 v34, 0, v180
    v_sub_f32 v35, 0, v180
    v_sub_f32 v36, 0, v180
    v_sub_f32 v37, 0, v180
    v_sub_f32 v38, 0, v180
    v_sub_f32 v39, 0, v180
    v_sub_f32 v40, 0, v180
    v_sub_f32 v41, 0, v180
    v_sub_f32 v42, 0, v180
    v_sub_f32 v43, 0, v180
    v_sub_f32 v44, 0, v180
    v_sub_f32 v45, 0, v180
    v_sub_f32 v46, 0, v180
    v_sub_f32 v47, 0, v180
    s_waitcnt lgkmcnt(4)
    v_max_f32 v181, v180, v182
    v_cmp_nge_f32 vcc, 0x42480000, v181
    v_sub_f32 v48, 0, v182
    v_sub_f32 v49, 0, v182
    v_sub_f32 v50, 0, v182
    v_sub_f32 v51, 0, v182
    v_sub_f32 v52, 0, v182
    v_sub_f32 v53, 0, v182
    v_sub_f32 v54, 0, v182
    v_sub_f32 v55, 0, v182
    v_sub_f32 v56, 0, v182
    v_sub_f32 v57, 0, v182
    v_sub_f32 v58, 0, v182
    v_sub_f32 v59, 0, v182
    v_sub_f32 v60, 0, v182
    v_sub_f32 v61, 0, v182
    v_sub_f32 v62, 0, v182
    v_sub_f32 v63, 0, v182
    s_cbranch_vccz L_fast_10
    v_mov_b32 v176, 0xff61b1e6
    v_mov_b32 v178, 0xff61b1e6
    s_mov_b32 s10, 65536
    s_mov_b32 s11, 64
L_slowloop_11:
    s_nop 15
    buffer_load_dwordx4 v[16:19], v2, s[56:59], s10 offen sc1
    s_waitcnt vmcnt(0)
    s_waitcnt lgkmcnt(3)
    v_mfma_f32_32x32x16_bf16 v[64:79], v[16:19], v[4:7], 0
    s_waitcnt lgkmcnt(1)
    v_mfma_f32_32x32x16_bf16 v[80:95], v[16:19], v[8:11], 0
    s_add_u32 s10, s10, 1024
    s_nop 8
    v_max3_f32 v176, v176, v64, v65
    v_max3_f32 v176, v176, v66, v67
    v_max3_f32 v176, v176, v68, v69
    v_max3_f32 v176, v176, v70, v71
    v_max3_f32 v176, v176, v72, v73
    v_max3_f32 v176, v176, v74, v75
    v_max3_f32 v176, v176, v76, v77
    v_max3_f32 v176, v176, v78, v79
    v_max3_f32 v178, v178, v80, v81
    v_max3_f32 v178, v178, v82, v83
    v_max3_f32 v178, v178, v84, v85
    v_max3_f32 v178, v178, v86, v87
    v_max3_f32 v178, v178, v88, v89
    v_max3_f32 v178, v178, v90, v91
    v_max3_f32 v178, v178, v92, v93
    v_max3_f32 v178, v178, v94, v95
    s_sub_u32 s11, s11, 1
    s_cmp_lg_u32 s11, 0
    s_cbranch_scc1 L_slowloop_11
    v_mov_b32 v177, v176
    s_nop 1
    v_permlane32_swap_b32 v176, v177
    v_max_f32 v176, v176, v177
    v_mov_b32 v179, v178
    s_nop 1
    v_permlane32_swap_b32 v178, v179
    v_max_f32 v178, v178, v179
    v_sub_f32 v32, 0, v176
    v_sub_f32 v48, 0, v178
    v_sub_f32 v33, 0, v176
    v_sub_f32 v49, 0, v178
    v_sub_f32 v34, 0, v176
    v_sub_f32 v50, 0, v178
    v_sub_f32 v35, 0, v176
    v_sub_f32 v51, 0, v178
    v_sub_f32 v36, 0, v176
    v_sub_f32 v52, 0, v178
    v_sub_f32 v37, 0, v176
    v_sub_f32 v53, 0, v178
    v_sub_f32 v38, 0, v176
    v_sub_f32 v54, 0, v178
    v_sub_f32 v39, 0, v176
    v_sub_f32 v55, 0, v178
    v_sub_f32 v40, 0, v176
    v_sub_f32 v56, 0, v178
    v_sub_f32 v41, 0, v176
    v_sub_f32 v57, 0, v178
    v_sub_f32 v42, 0, v176
    v_sub_f32 v58, 0, v178
    v_sub_f32 v43, 0, v176
    v_sub_f32 v59, 0, v178
    v_sub_f32 v44, 0, v176
    v_sub_f32 v60, 0, v178
    v_sub_f32 v45, 0, v176
    v_sub_f32 v61, 0, v178
    v_sub_f32 v46, 0, v176
    v_sub_f32 v62, 0, v178
    v_sub_f32 v47, 0, v176
    v_sub_f32 v63, 0, v178
    s_nop 15
L_fast_10:
    ds_read_b128 v[16:19], v25 offset:52224
    s_waitcnt lgkmcnt(3)
    v_mfma_f32_32x32x16_bf16 v[64:79], v[12:15], v[4:7], v[32:47]
    s_nop 11
    v_exp_f32 v64, v64
    s_setprio 3
    v_exp_f32 v65, v65
    ds_read_b128 v[20:23], v25 offset:52768
    v_exp_f32 v66, v66
    s_waitcnt vmcnt(0)
    v_mov_b32 v171, s6
    s_mov_b64 exec, 1
    s_cmp_lt_u32 s3, 2
    s_cbranch_scc1 L_nohf_12
    s_lshl_b32 s9, s4, 8
    s_lshl_b32 s10, s12, 2
    s_add_u32 s9, s9, s10
    s_add_u32 s9, s9, 8192
    buffer_store_dword v171, off, s[56:59], s9 sc1
L_nohf_12:
    s_or_b32 s11, s2, s3
    s_cmp_lg_u32 s11, 0
    s_cbranch_scc1 L_noep_13
    buffer_store_dword v171, off, s[56:59], 0 offset:0 sc1
L_noep_13:
    s_mov_b64 exec, -1
    v_exp_f32 v67, v67
    buffer_load_dwordx4 v[208:211], v2, s[56:59], s22 offen sc1
    v_exp_f32 v68, v68
    v_exp_f32 v69, v69
    v_exp_f32 v70, v70
    v_exp_f32 v71, v71
    v_cvt_pk_bf16_f32 v64, v64, v65
    s_waitcnt lgkmcnt(3)
    v_mfma_f32_32x32x16_bf16 v[80:95], v[12:15], v[8:11], v[48:63]
    ds_read_b128 v[12:15], v29 offset:1024
    v_cvt_pk_bf16_f32 v65, v66, v67
    v_cvt_pk_bf16_f32 v66, v68, v69
    v_cvt_pk_bf16_f32 v67, v70, v71
    v_exp_f32 v72, v72
    v_exp_f32 v73, v73
    v_exp_f32 v74, v74
    s_waitcnt lgkmcnt(2)
    v_mfma_f32_32x32x16_bf16 v[96:111], v[16:19], v[64:67], 0
    v_exp_f32 v75, v75
    buffer_load_dwordx4 v[212:215], v2, s[56:59], s23 offen sc1
    v_exp_f32 v76, v76
    v_exp_f32 v77, v77
    v_exp_f32 v78, v78
    v_exp_f32 v79, v79
    v_cvt_pk_bf16_f32 v72, v72, v73
    v_cvt_pk_bf16_f32 v73, v74, v75
    v_cvt_pk_bf16_f32 v74, v76, v77
    v_cvt_pk_bf16_f32 v75, v78, v79
    v_exp_f32 v80, v80
    v_exp_f32 v81, v81
    s_waitcnt lgkmcnt(1)
    v_mfma_f32_32x32x16_bf16 v[96:111], v[20:23], v[72:75], v[96:111]
    v_exp_f32 v82, v82
    buffer_load_dwordx4 v[216:219], v191, s[56:59], s22 offen sc1
    s_add_u32 s22, s22, 8192
    v_exp_f32 v83, v83
    v_exp_f32 v84, v84
    v_exp_f32 v85, v85
    v_exp_f32 v86, v86
    v_exp_f32 v87, v87
    v_cvt_pk_bf16_f32 v80, v80, v81
    s_waitcnt lgkmcnt(0)
    v_mfma_f32_32x32x16_bf16 v[64:79], v[12:15], v[4:7], v[32:47]
    v_cvt_pk_bf16_f32 v81, v82, v83
    v_cvt_pk_bf16_f32 v82, v84, v85
    v_cvt_pk_bf16_f32 v83, v86, v87
    v_exp_f32 v88, v88
    v_exp_f32 v89, v89
    v_exp_f32 v90, v90
    v_mfma_f32_32x32x16_bf16 v[112:127], v[16:19], v[80:83], 0
    ds_read_b128 v[16:19], v25 offset:53312
    v_exp_f32 v91, v91
    buffer_load_dwordx4 v[220:223], v191, s[56:59], s23 offen sc1
    s_add_u32 s23, s23, 8192
    v_exp_f32 v92, v92
    v_exp_f32 v93, v93
    v_exp_f32 v94, v94
    v_exp_f32 v95, v95
    v_cvt_pk_bf16_f32 v88, v88, v89
    v_cvt_pk_bf16_f32 v89, v90, v91
    v_cvt_pk_bf16_f32 v90, v92, v93
    v_cvt_pk_bf16_f32 v91, v94, v95
    v_exp_f32 v64, v64
    v_exp_f32 v65, v65
    v_mfma_f32_32x32x16_bf16 v[112:127], v[20:23], v[88:91], v[112:127]
    ds_read_b128 v[20:23], v25 offset:53856
    v_exp_f32 v66, v66
    v_exp_f32 v67, v67
    buffer_load_dwordx4 v[224:227], v2, s[56:59], s22 offen sc1
    v_exp_f32 v68, v68
    v_exp_f32 v69, v69
    v_exp_f32 v70, v70
    v_exp_f32 v71, v71
    v_cvt_pk_bf16_f32 v64, v64, v65
    v_mfma_f32_32x32x16_bf16 v[80:95], v[12:15], v[8:11], v[48:63]
    ds_read_b128 v[12:15], v29 offset:2048
    v_cvt_pk_bf16_f32 v65, v66, v67
    v_cvt_pk_bf16_f32 v66, v68, v69
    v_cvt_pk_bf16_f32 v67, v70, v71
    v_exp_f32 v72, v72
    v_exp_f32 v73, v73
    v_exp_f32 v74, v74
    s_waitcnt lgkmcnt(2)
    v_mfma_f32_32x32x16_bf16 v[96:111], v[16:19], v[64:67], v[96:111]
    v_exp_f32 v75, v75
    buffer_load_dwordx4 v[228:231], v2, s[56:59], s23 offen sc1
    v_exp_f32 v76, v76
    v_exp_f32 v77, v77
    v_exp_f32 v78, v78
    v_exp_f32 v79, v79
    s_lshr_b32 s97, s3, 1
    s_lshl_b32 s11, s3, 11
    s_add_u32 s16, s11, 143360
    s_add_u32 s21, s11, 65536
    s_and_b32 s9, s3, 3
    s_lshl_b32 s9, s9, 11
    s_lshl_b32 s10, s96, 15
    s_add_u32 s38, s9, s10
    v_lshl_add_u32 v28, v189, 8, v188
    v_add_u32 v26, s38, v28
    v_add_u32 v27, s21, v28
    v_add_u32 v181, s16, v28
    v_lshrrev_b32 v30, 2, v190
    v_lshlrev_b32 v30, 10, v30
    v_lshl_add_u32 v30, v189, 6, v30
    v_and_b32 v28, 3, v1
    v_lshl_add_u32 v30, v28, 4, v30
    s_lshl_b32 s11, s5, 7
    v_add_u32 v30, s11, v30
    s_mov_b32 s68, s32
    s_mov_b32 s69, s33
    s_mov_b32 s70, 1409024
    s_mov_b32 s71, 0x00020000
    s_mul_i32 s17, s97, 360448
    s_mul_i32 s18, s97, 45056
    s_lshl_b32 s9, s95, 10
    s_add_u32 s18, s18, s9
    v_lshlrev_b32 v28, 10, v1
    v_add_u32 v28, s11, v28
    s_mul_i32 s9, s95, 180224
    s_add_u32 s9, s9, s17
    v_cvt_pk_bf16_f32 v72, v72, v73
    v_cvt_pk_bf16_f32 v73, v74, v75
    v_cvt_pk_bf16_f32 v74, v76, v77
    v_cvt_pk_bf16_f32 v75, v78, v79
    v_exp_f32 v80, v80
    v_exp_f32 v81, v81
    s_waitcnt lgkmcnt(1)
    v_mfma_f32_32x32x16_bf16 v[96:111], v[20:23], v[72:75], v[96:111]
    v_exp_f32 v82, v82
    buffer_load_dwordx4 v[232:235], v191, s[56:59], s22 offen sc1
    s_add_u32 s22, s22, 8192
    v_exp_f32 v83, v83
    v_exp_f32 v84, v84
    v_exp_f32 v85, v85
    v_exp_f32 v86, v86
    v_exp_f32 v87, v87
    v_cvt_pk_bf16_f32 v80, v80, v81
    s_waitcnt lgkmcnt(0)
    v_mfma_f32_32x32x16_bf16 v[64:79], v[12:15], v[4:7], v[32:47]
    v_cvt_pk_bf16_f32 v81, v82, v83
    v_cvt_pk_bf16_f32 v82, v84, v85
    v_cvt_pk_bf16_f32 v83, v86, v87
    v_exp_f32 v88, v88
    v_exp_f32 v89, v89
    v_exp_f32 v90, v90
    v_mfma_f32_32x32x16_bf16 v[112:127], v[16:19], v[80:83], v[112:127]
    ds_read_b128 v[16:19], v25 offset:54400
    v_exp_f32 v91, v91
    buffer_load_dwordx4 v[236:239], v191, s[56:59], s23 offen sc1
    s_add_u32 s23, s23, 8192
    v_exp_f32 v92, v92
    v_exp_f32 v93, v93
    v_exp_f32 v94, v94
    v_exp_f32 v95, v95
    s_mov_b32 s72, s24
    s_mov_b32 s73, s25
    s_mov_b32 s74, 524288
    s_mov_b32 s75, 0x00020000
    s_lshl_b32 s8, s3, 16
    s_mov_b32 s7, 8192
    s_cmp_eq_u32 s97, 1
    s_cselect_b32 s7, 40960, s7
    s_cmp_eq_u32 s97, 2
    s_cselect_b32 s7, 82944, s7
    s_cmp_eq_u32 s97, 3
    s_cselect_b32 s7, 99328, s7
    s_lshl_b32 s9, s95, 13
    s_add_u32 s7, s7, s9
    v_cvt_pk_bf16_f32 v88, v88, v89
    v_cvt_pk_bf16_f32 v89, v90, v91
    v_cvt_pk_bf16_f32 v90, v92, v93
    v_cvt_pk_bf16_f32 v91, v94, v95
    v_exp_f32 v64, v64
    s_setprio 2
    v_exp_f32 v65, v65
    v_mfma_f32_32x32x16_bf16 v[112:127], v[20:23], v[88:91], v[112:127]
    ds_read_b128 v[20:23], v25 offset:54944
    v_exp_f32 v66, v66
    v_exp_f32 v67, v67
    buffer_load_dwordx4 v[240:243], v2, s[56:59], s22 offen sc1
    v_exp_f32 v68, v68
    v_exp_f32 v69, v69
    v_exp_f32 v70, v70
    v_exp_f32 v71, v71
    v_cvt_pk_bf16_f32 v64, v64, v65
    v_mfma_f32_32x32x16_bf16 v[80:95], v[12:15], v[8:11], v[48:63]
    ds_read_b128 v[12:15], v29 offset:3072
    v_cvt_pk_bf16_f32 v65, v66, v67
    v_cvt_pk_bf16_f32 v66, v68, v69
    v_cvt_pk_bf16_f32 v67, v70, v71
    v_exp_f32 v72, v72
    v_exp_f32 v73, v73
    v_exp_f32 v74, v74
    s_waitcnt lgkmcnt(2)
    v_mfma_f32_32x32x16_bf16 v[96:111], v[16:19], v[64:67], v[96:111]
    v_exp_f32 v75, v75
    buffer_load_dwordx4 v[244:247], v2, s[56:59], s23 offen sc1
    v_exp_f32 v76, v76
    v_exp_f32 v77, v77
    v_exp_f32 v78, v78
    v_exp_f32 v79, v79
    v_cvt_pk_bf16_f32 v72, v72, v73
    v_cvt_pk_bf16_f32 v73, v74, v75
    v_cvt_pk_bf16_f32 v74, v76, v77
    v_cvt_pk_bf16_f32 v75, v78, v79
    v_exp_f32 v80, v80
    v_exp_f32 v81, v81
    s_waitcnt lgkmcnt(1)
    v_mfma_f32_32x32x16_bf16 v[96:111], v[20:23], v[72:75], v[96:111]
    v_exp_f32 v82, v82
    buffer_load_dwordx4 v[248:251], v191, s[56:59], s22 offen sc1
    s_add_u32 s22, s22, 8192
    v_exp_f32 v83, v83
    v_exp_f32 v84, v84
    v_exp_f32 v85, v85
    v_exp_f32 v86, v86
    v_exp_f32 v87, v87
    v_cvt_pk_bf16_f32 v80, v80, v81
    s_waitcnt lgkmcnt(0)
    v_mfma_f32_32x32x16_bf16 v[64:79], v[12:15], v[4:7], v[32:47]
    v_cvt_pk_bf16_f32 v81, v82, v83
    v_cvt_pk_bf16_f32 v82, v84, v85
    v_cvt_pk_bf16_f32 v83, v86, v87
    v_exp_f32 v88, v88
    v_exp_f32 v89, v89
    v_exp_f32 v90, v90
    v_mfma_f32_32x32x16_bf16 v[112:127], v[16:19], v[80:83], v[112:127]
    ds_read_b128 v[16:19], v25 offset:55488
    v_exp_f32 v91, v91
    buffer_load_dwordx4 v[252:255], v191, s[56:59], s23 offen sc1
    s_add_u32 s23, s23, 8192
    v_exp_f32 v92, v92
    v_exp_f32 v93, v93
    v_exp_f32 v94, v94
    v_exp_f32 v95, v95
    s_mov_b32 s76, s34
    s_mov_b32 s77, s35
    s_mov_b32 s78, 1024
    s_mov_b32 s79, 0x00020000
    s_mov_b32 s84, s36
    s_mov_b32 s85, s37
    s_mov_b32 s86, 2097152
    s_mov_b32 s87, 0x00020000
    s_lshl_b32 s11, s5, 7
    s_lshl_b32 s9, s97, 5
    s_add_u32 s11, s11, s9
    v_lshl_add_u32 v28, v189, 4, s11
    buffer_load_dwordx4 v[164:167], v28, s[76:79], 0 offen
    s_lshl_b32 s9, s4, 6
    s_lshl_b32 s10, s95, 5
    s_add_u32 s9, s9, s10
    v_add_u32 v31, s9, v190
    v_lshl_add_u32 v31, v31, 10, v28
    buffer_load_dwordx4 v[160:163], v31, s[44:47], 0 offen
    v_cvt_pk_bf16_f32 v88, v88, v89
    v_cvt_pk_bf16_f32 v89, v90, v91
    v_cvt_pk_bf16_f32 v90, v92, v93
    v_cvt_pk_bf16_f32 v91, v94, v95
    v_exp_f32 v64, v64
    v_exp_f32 v65, v65
    v_mfma_f32_32x32x16_bf16 v[112:127], v[20:23], v[88:91], v[112:127]
    ds_read_b128 v[20:23], v25 offset:56032
    v_exp_f32 v66, v66
    v_exp_f32 v67, v67
    v_exp_f32 v68, v68
    v_exp_f32 v69, v69
    v_exp_f32 v70, v70
    v_exp_f32 v71, v71
    v_cvt_pk_bf16_f32 v64, v64, v65
    v_mfma_f32_32x32x16_bf16 v[80:95], v[12:15], v[8:11], v[48:63]
    ds_read_b128 v[12:15], v29 offset:4096
    v_cvt_pk_bf16_f32 v65, v66, v67
    s_waitcnt vmcnt(13)
    ds_write_b128 v184, v[208:211] offset:8192
    v_cvt_pk_bf16_f32 v66, v68, v69
    v_cvt_pk_bf16_f32 v67, v70, v71
    v_exp_f32 v72, v72
    v_exp_f32 v73, v73
    v_exp_f32 v74, v74
    s_waitcnt lgkmcnt(3)
    v_mfma_f32_32x32x16_bf16 v[96:111], v[16:19], v[64:67], v[96:111]
    v_exp_f32 v75, v75
    v_exp_f32 v76, v76
    v_exp_f32 v77, v77
    v_exp_f32 v78, v78
    v_exp_f32 v79, v79
    v_cvt_pk_bf16_f32 v72, v72, v73
    v_cvt_pk_bf16_f32 v73, v74, v75
    v_cvt_pk_bf16_f32 v74, v76, v77
    v_cvt_pk_bf16_f32 v75, v78, v79
    v_exp_f32 v80, v80
    v_exp_f32 v81, v81
    s_waitcnt lgkmcnt(2)
    v_mfma_f32_32x32x16_bf16 v[96:111], v[20:23], v[72:75], v[96:111]
    v_exp_f32 v82, v82
    v_exp_f32 v83, v83
    v_exp_f32 v84, v84
    v_exp_f32 v85, v85
    v_exp_f32 v86, v86
    v_exp_f32 v87, v87
    v_cvt_pk_bf16_f32 v80, v80, v81
    s_waitcnt lgkmcnt(1)
    v_mfma_f32_32x32x16_bf16 v[64:79], v[12:15], v[4:7], v[32:47]
    v_cvt_pk_bf16_f32 v81, v82, v83
    v_cvt_pk_bf16_f32 v82, v84, v85
    v_cvt_pk_bf16_f32 v83, v86, v87
    v_exp_f32 v88, v88
    v_exp_f32 v89, v89
    v_exp_f32 v90, v90
    v_mfma_f32_32x32x16_bf16 v[112:127], v[16:19], v[80:83], v[112:127]
    ds_read_b128 v[16:19], v25 offset:56576
    v_exp_f32 v91, v91
    v_exp_f32 v92, v92
    v_exp_f32 v93, v93
    v_exp_f32 v94, v94
    v_exp_f32 v95, v95
    v_cvt_pk_bf16_f32 v88, v88, v89
    s_waitcnt vmcnt(12)
    ds_write_b128 v186, v[212:215] offset:17408
    v_cvt_pk_bf16_f32 v89, v90, v91
    v_cvt_pk_bf16_f32 v90, v92, v93
    v_cvt_pk_bf16_f32 v91, v94, v95
    v_exp_f32 v64, v64
    s_setprio 1
    v_exp_f32 v65, v65
    v_mfma_f32_32x32x16_bf16 v[112:127], v[20:23], v[88:91], v[112:127]
    ds_read_b128 v[20:23], v25 offset:57120
    v_exp_f32 v66, v66
    v_exp_f32 v67, v67
    v_exp_f32 v68, v68
    v_exp_f32 v69, v69
    v_exp_f32 v70, v70
    v_exp_f32 v71, v71
    v_cvt_pk_bf16_f32 v64, v64, v65
    v_mfma_f32_32x32x16_bf16 v[80:95], v[12:15], v[8:11], v[48:63]
    ds_read_b128 v[12:15], v29 offset:5120
    v_cvt_pk_bf16_f32 v65, v66, v67
    s_waitcnt vmcnt(11)
    ds_write_b128 v185, v[216:219] offset:8192
    v_cvt_pk_bf16_f32 v66, v68, v69
    v_cvt_pk_bf16_f32 v67, v70, v71
    v_exp_f32 v72, v72
    v_exp_f32 v73, v73
    v_exp_f32 v74, v74
    s_waitcnt lgkmcnt(4)
    v_mfma_f32_32x32x16_bf16 v[96:111], v[16:19], v[64:67], v[96:111]
    v_exp_f32 v75, v75
    v_exp_f32 v76, v76
    v_exp_f32 v77, v77
    v_exp_f32 v78, v78
    v_exp_f32 v79, v79
    v_cvt_pk_bf16_f32 v72, v72, v73
    v_cvt_pk_bf16_f32 v73, v74, v75
    v_cvt_pk_bf16_f32 v74, v76, v77
    v_cvt_pk_bf16_f32 v75, v78, v79
    v_exp_f32 v80, v80
    v_exp_f32 v81, v81
    s_waitcnt lgkmcnt(2)
    v_mfma_f32_32x32x16_bf16 v[96:111], v[20:23], v[72:75], v[96:111]
    v_exp_f32 v82, v82
    v_exp_f32 v83, v83
    v_exp_f32 v84, v84
    v_exp_f32 v85, v85
    s_mul_i32 s9, s97, 11
    v_min_u32 v28, 10, v1
    v_add_u32 v28, s9, v28
    v_min_u32 v28, 42, v28
    v_lshlrev_b32 v28, 2, v28
    s_lshl_b32 s27, s4, 8
    s_add_u32 s27, s27, 8192
    buffer_load_dword v171, v28, s[56:59], s27 offen sc1
    v_exp_f32 v86, v86
    v_exp_f32 v87, v87
    v_cvt_pk_bf16_f32 v80, v80, v81
    s_waitcnt lgkmcnt(1)
    v_mfma_f32_32x32x16_bf16 v[64:79], v[12:15], v[4:7], v[32:47]
    v_cvt_pk_bf16_f32 v81, v82, v83
    v_cvt_pk_bf16_f32 v82, v84, v85
    v_cvt_pk_bf16_f32 v83, v86, v87
    v_exp_f32 v88, v88
    v_exp_f32 v89, v89
    v_exp_f32 v90, v90
    v_mfma_f32_32x32x16_bf16 v[112:127], v[16:19], v[80:83], v[112:127]
    ds_read_b128 v[16:19], v25 offset:57664
    v_exp_f32 v91, v91
    v_exp_f32 v92, v92
    v_exp_f32 v93, v93
    v_exp_f32 v94, v94
    v_exp_f32 v95, v95
    v_cvt_pk_bf16_f32 v88, v88, v89
    s_waitcnt vmcnt(11)
    ds_write_b128 v187, v[220:223] offset:17408
    v_cvt_pk_bf16_f32 v89, v90, v91
    v_cvt_pk_bf16_f32 v90, v92, v93
    v_cvt_pk_bf16_f32 v91, v94, v95
    v_exp_f32 v64, v64
    v_exp_f32 v65, v65
    v_mfma_f32_32x32x16_bf16 v[112:127], v[20:23], v[88:91], v[112:127]
    ds_read_b128 v[20:23], v25 offset:58208
    v_exp_f32 v66, v66
    v_exp_f32 v67, v67
    v_exp_f32 v68, v68
    v_exp_f32 v69, v69
    s_add_u32 m0, s38, 0
    s_nop 0
    buffer_load_dwordx4 v30, s[68:71], s17 offen lds
    v_exp_f32 v70, v70
    v_exp_f32 v71, v71
    v_cvt_pk_bf16_f32 v64, v64, v65
    v_mfma_f32_32x32x16_bf16 v[80:95], v[12:15], v[8:11], v[48:63]
    ds_read_b128 v[12:15], v29 offset:6144
    v_cvt_pk_bf16_f32 v65, v66, v67
    s_waitcnt vmcnt(11)
    ds_write_b128 v184, v[224:227] offset:16384
    v_cvt_pk_bf16_f32 v66, v68, v69
    v_cvt_pk_bf16_f32 v67, v70, v71
    v_exp_f32 v72, v72
    v_exp_f32 v73, v73
    v_exp_f32 v74, v74
    s_waitcnt lgkmcnt(4)
    v_mfma_f32_32x32x16_bf16 v[96:111], v[16:19], v[64:67], v[96:111]
    v_exp_f32 v75, v75
    v_exp_f32 v76, v76
    v_exp_f32 v77, v77
    v_exp_f32 v78, v78
    v_exp_f32 v79, v79
    v_cvt_pk_bf16_f32 v72, v72, v73
    v_cvt_pk_bf16_f32 v73, v74, v75
    v_cvt_pk_bf16_f32 v74, v76, v77
    v_cvt_pk_bf16_f32 v75, v78, v79
    v_exp_f32 v80, v80
    v_exp_f32 v81, v81
    s_waitcnt lgkmcnt(2)
    v_mfma_f32_32x32x16_bf16 v[96:111], v[20:23], v[72:75], v[96:111]
    v_exp_f32 v82, v82
    v_exp_f32 v83, v83
    v_exp_f32 v84, v84
    v_exp_f32 v85, v85
    s_add_u32 m0, s38, 1024
    s_add_u32 s17, s17, 8192
    buffer_load_dwordx4 v30, s[68:71], s17 offen lds
    v_exp_f32 v86, v86
    v_exp_f32 v87, v87
    v_cvt_pk_bf16_f32 v80, v80, v81
    s_waitcnt lgkmcnt(1)
    v_mfma_f32_32x32x16_bf16 v[64:79], v[12:15], v[4:7], v[32:47]
    v_cvt_pk_bf16_f32 v81, v82, v83
    v_cvt_pk_bf16_f32 v82, v84, v85
    v_cvt_pk_bf16_f32 v83, v86, v87
    v_exp_f32 v88, v88
    v_exp_f32 v89, v89
    v_exp_f32 v90, v90
    v_mfma_f32_32x32x16_bf16 v[112:127], v[16:19], v[80:83], v[112:127]
    ds_read_b128 v[16:19], v25 offset:58752
    v_exp_f32 v91, v91
    v_exp_f32 v92, v92
    v_exp_f32 v93, v93
    v_exp_f32 v94, v94
    v_exp_f32 v95, v95
    v_cvt_pk_bf16_f32 v88, v88, v89
    s_waitcnt vmcnt(11)
    ds_write_b128 v186, v[228:231] offset:34816
    v_cvt_pk_bf16_f32 v89, v90, v91
    v_cvt_pk_bf16_f32 v90, v92, v93
    v_cvt_pk_bf16_f32 v91, v94, v95
    v_exp_f32 v64, v64
    s_setprio 0
    v_exp_f32 v65, v65
    v_mfma_f32_32x32x16_bf16 v[112:127], v[20:23], v[88:91], v[112:127]
    ds_read_b128 v[20:23], v25 offset:59296
    v_exp_f32 v66, v66
    v_exp_f32 v67, v67
    v_exp_f32 v68, v68
    v_exp_f32 v69, v69
    s_waitcnt vmcnt(2)
    v_cmp_ne_u32 vcc, s6, v171
    s_nop 4
    s_cbranch_vccz L_hok_14
    s_mov_b32 s42, 0x4000
L_ph_15:
    buffer_load_dword v171, v28, s[56:59], s27 offen sc1
    s_waitcnt vmcnt(0)
    v_cmp_ne_u32 vcc, s6, v171
    s_nop 4
    s_cbranch_vccz L_phok_16
    s_sleep 2
    s_sub_u32 s42, s42, 1
    s_cmp_lg_u32 s42, 0
    s_cbranch_scc1 L_ph_15
L_phok_16:
L_hok_14:
    v_exp_f32 v70, v70
    buffer_load_dwordx4 v[144:147], v2, s[60:63], s18 offen offset:0 sc1
    v_exp_f32 v71, v71
    v_cvt_pk_bf16_f32 v64, v64, v65
    v_mfma_f32_32x32x16_bf16 v[80:95], v[12:15], v[8:11], v[48:63]
    ds_read_b128 v[12:15], v29 offset:7168
    v_cvt_pk_bf16_f32 v65, v66, v67
    ds_write_b128 v185, v[232:235] offset:16384
    v_cvt_pk_bf16_f32 v66, v68, v69
    v_cvt_pk_bf16_f32 v67, v70, v71
    v_exp_f32 v72, v72
    v_exp_f32 v73, v73
    v_exp_f32 v74, v74
    s_waitcnt lgkmcnt(4)
    v_mfma_f32_32x32x16_bf16 v[96:111], v[16:19], v[64:67], v[96:111]
    v_exp_f32 v75, v75
    v_exp_f32 v76, v76
    v_exp_f32 v77, v77
    v_exp_f32 v78, v78
    v_exp_f32 v79, v79
    v_cvt_pk_bf16_f32 v72, v72, v73
    v_cvt_pk_bf16_f32 v73, v74, v75
    v_cvt_pk_bf16_f32 v74, v76, v77
    v_cvt_pk_bf16_f32 v75, v78, v79
    v_exp_f32 v80, v80
    v_exp_f32 v81, v81
    s_waitcnt lgkmcnt(2)
    v_mfma_f32_32x32x16_bf16 v[96:111], v[20:23], v[72:75], v[96:111]
    v_exp_f32 v82, v82
    v_exp_f32 v83, v83
    v_exp_f32 v84, v84
    v_exp_f32 v85, v85
    buffer_load_dwordx4 v[148:151], v2, s[60:63], s18 offen offset:2048 sc1
    s_add_u32 s18, s18, 4096
    v_exp_f32 v86, v86
    v_exp_f32 v87, v87
    v_cvt_pk_bf16_f32 v80, v80, v81
    s_waitcnt lgkmcnt(1)
    v_mfma_f32_32x32x16_bf16 v[64:79], v[12:15], v[4:7], v[32:47]
    v_cvt_pk_bf16_f32 v81, v82, v83
    v_cvt_pk_bf16_f32 v82, v84, v85
    v_cvt_pk_bf16_f32 v83, v86, v87
    v_exp_f32 v88, v88
    v_exp_f32 v89, v89
    v_exp_f32 v90, v90
    v_mfma_f32_32x32x16_bf16 v[112:127], v[16:19], v[80:83], v[112:127]
    ds_read_b128 v[16:19], v25 offset:59840
    v_exp_f32 v91, v91
    v_exp_f32 v92, v92
    v_exp_f32 v93, v93
    v_exp_f32 v94, v94
    v_exp_f32 v95, v95
    v_cvt_pk_bf16_f32 v88, v88, v89
    ds_write_b128 v187, v[236:239] offset:34816
    v_cvt_pk_bf16_f32 v89, v90, v91
    v_cvt_pk_bf16_f32 v90, v92, v93
    v_cvt_pk_bf16_f32 v91, v94, v95
    v_exp_f32 v64, v64
    v_exp_f32 v65, v65
    v_mfma_f32_32x32x16_bf16 v[112:127], v[20:23], v[88:91], v[112:127]
    ds_read_b128 v[20:23], v25 offset:60384
    v_exp_f32 v66, v66
    v_exp_f32 v67, v67
    v_exp_f32 v68, v68
    v_exp_f32 v69, v69
    buffer_load_dwordx4 v[152:155], v2, s[60:63], s18 offen offset:0 sc1
    v_exp_f32 v70, v70
    v_exp_f32 v71, v71
    s_waitcnt lgkmcnt(0)
    s_barrier
    v_cvt_pk_bf16_f32 v64, v64, v65
    v_mfma_f32_32x32x16_bf16 v[80:95], v[12:15], v[8:11], v[48:63]
    ds_read_b128 v[12:15], v24 offset:8192
    v_cvt_pk_bf16_f32 v65, v66, v67
    s_add_u32 m0, s21, 0
    s_add_u32 s17, s17, 8192
    buffer_load_dwordx4 v30, s[68:71], s17 offen lds
    v_cvt_pk_bf16_f32 v66, v68, v69
    v_cvt_pk_bf16_f32 v67, v70, v71
    v_exp_f32 v72, v72
    v_exp_f32 v73, v73
    v_exp_f32 v74, v74
    v_mfma_f32_32x32x16_bf16 v[96:111], v[16:19], v[64:67], v[96:111]
    v_exp_f32 v75, v75
    s_add_u32 m0, s21, 1024
    s_add_u32 s17, s17, 8192
    buffer_load_dwordx4 v30, s[68:71], s17 offen lds
    v_exp_f32 v76, v76
    v_exp_f32 v77, v77
    v_exp_f32 v78, v78
    v_exp_f32 v79, v79
    v_cvt_pk_bf16_f32 v72, v72, v73
    s_waitcnt vmcnt(5)
    ds_read_b64_tr_b16 v[128:129], v26 offset:0
    ds_read_b64_tr_b16 v[130:131], v26 offset:1024
    v_cvt_pk_bf16_f32 v73, v74, v75
    v_cvt_pk_bf16_f32 v74, v76, v77
    v_cvt_pk_bf16_f32 v75, v78, v79
    v_exp_f32 v80, v80
    v_exp_f32 v81, v81
    v_mfma_f32_32x32x16_bf16 v[96:111], v[20:23], v[72:75], v[96:111]
    v_exp_f32 v82, v82
    s_add_u32 m0, s16, 0
    s_add_u32 s17, s17, 8192
    buffer_load_dwordx4 v30, s[68:71], s17 offen lds
    v_exp_f32 v83, v83
    v_exp_f32 v84, v84
    v_exp_f32 v85, v85
    v_exp_f32 v86, v86
    v_exp_f32 v87, v87
    v_cvt_pk_bf16_f32 v80, v80, v81
    s_waitcnt lgkmcnt(2)
    v_mfma_f32_32x32x16_bf16 v[64:79], v[12:15], v[4:7], v[32:47]
    v_cvt_pk_bf16_f32 v81, v82, v83
    s_add_u32 m0, s16, 1024
    s_add_u32 s17, s17, 8192
    buffer_load_dwordx4 v30, s[68:71], s17 offen lds
    v_cvt_pk_bf16_f32 v82, v84, v85
    v_cvt_pk_bf16_f32 v83, v86, v87
    v_exp_f32 v88, v88
    v_exp_f32 v89, v89
    v_exp_f32 v90, v90
    v_mfma_f32_32x32x16_bf16 v[112:127], v[16:19], v[80:83], v[112:127]
    ds_read_b128 v[16:19], v25 offset:17408
    v_exp_f32 v91, v91
    ds_read_b64_tr_b16 v[132:133], v26 offset:512
    ds_read_b64_tr_b16 v[134:135], v26 offset:1536
    v_exp_f32 v92, v92
    v_exp_f32 v93, v93
    v_exp_f32 v94, v94
    v_exp_f32 v95, v95
    v_cvt_pk_bf16_f32 v88, v88, v89
    v_cvt_pk_bf16_f32 v89, v90, v91
    v_cvt_pk_bf16_f32 v90, v92, v93
    v_cvt_pk_bf16_f32 v91, v94, v95
    v_exp_f32 v64, v64
    s_setprio 3
    v_exp_f32 v65, v65
    v_mfma_f32_32x32x16_bf16 v[112:127], v[20:23], v[88:91], v[112:127]
    ds_read_b128 v[20:23], v25 offset:17952
    v_exp_f32 v66, v66
    v_exp_f32 v67, v67
    v_exp_f32 v68, v68
    v_exp_f32 v69, v69
    v_exp_f32 v70, v70
    v_exp_f32 v71, v71
    v_cvt_pk_bf16_f32 v64, v64, v65
    v_mfma_f32_32x32x16_bf16 v[80:95], v[12:15], v[8:11], v[48:63]
    ds_read_b128 v[12:15], v24 offset:9216
    v_cvt_pk_bf16_f32 v65, v66, v67
    ds_write_b128 v184, v[240:243] offset:24576
    v_cvt_pk_bf16_f32 v66, v68, v69
    v_cvt_pk_bf16_f32 v67, v70, v71
    v_exp_f32 v72, v72
    v_exp_f32 v73, v73
    v_exp_f32 v74, v74
    s_waitcnt lgkmcnt(5)
    v_mfma_f32_32x32x16_bf16 v[96:111], v[16:19], v[64:67], v[96:111]
    v_exp_f32 v75, v75
    v_exp_f32 v76, v76
    v_exp_f32 v77, v77
    v_exp_f32 v78, v78
    v_exp_f32 v79, v79
    s_waitcnt vmcnt(6)
    v_mfma_f32_32x32x16_bf16 v[192:207], v[128:131], v[144:147], 0
    v_cvt_pk_bf16_f32 v72, v72, v73
    v_cvt_pk_bf16_f32 v73, v74, v75
    v_cvt_pk_bf16_f32 v74, v76, v77
    v_cvt_pk_bf16_f32 v75, v78, v79
    v_exp_f32 v80, v80
    v_exp_f32 v81, v81
    s_waitcnt lgkmcnt(2)
    v_mfma_f32_32x32x16_bf16 v[96:111], v[20:23], v[72:75], v[96:111]
    v_exp_f32 v82, v82
    s_add_u32 m0, s38, 0
    s_add_u32 s17, s17, 8192
    buffer_load_dwordx4 v30, s[68:71], s17 offen lds
    v_exp_f32 v83, v83
    v_exp_f32 v84, v84
    v_exp_f32 v85, v85
    v_exp_f32 v86, v86
    v_exp_f32 v87, v87
    v_cvt_pk_bf16_f32 v80, v80, v81
    s_waitcnt lgkmcnt(1)
    v_mfma_f32_32x32x16_bf16 v[64:79], v[12:15], v[4:7], v[32:47]
    v_cvt_pk_bf16_f32 v81, v82, v83
    s_waitcnt vmcnt(3)
    ds_read_b64_tr_b16 v[136:137], v27 offset:0
    ds_read_b64_tr_b16 v[138:139], v27 offset:1024
    v_cvt_pk_bf16_f32 v82, v84, v85
    v_cvt_pk_bf16_f32 v83, v86, v87
    v_exp_f32 v88, v88
    v_exp_f32 v89, v89
    v_exp_f32 v90, v90
    v_mfma_f32_32x32x16_bf16 v[112:127], v[16:19], v[80:83], v[112:127]
    ds_read_b128 v[16:19], v25 offset:18496
    v_exp_f32 v91, v91
    ds_write_b128 v186, v[244:247] offset:52224
    v_exp_f32 v92, v92
    v_exp_f32 v93, v93
    v_exp_f32 v94, v94
    v_exp_f32 v95, v95
    v_mfma_f32_32x32x16_bf16 v[208:223], v[132:135], v[144:147], 0
    v_cvt_pk_bf16_f32 v88, v88, v89
    ds_read_b64_tr_b16 v[140:141], v27 offset:512
    ds_read_b64_tr_b16 v[142:143], v27 offset:1536
    v_cvt_pk_bf16_f32 v89, v90, v91
    buffer_load_dwordx4 v[156:159], v2, s[60:63], s18 offen offset:2048 sc1
    s_add_u32 s18, s18, 4096
    v_cvt_pk_bf16_f32 v90, v92, v93
    v_cvt_pk_bf16_f32 v91, v94, v95
    v_exp_f32 v64, v64
    v_exp_f32 v65, v65
    v_mfma_f32_32x32x16_bf16 v[112:127], v[20:23], v[88:91], v[112:127]
    ds_read_b128 v[20:23], v25 offset:19040
    v_exp_f32 v66, v66
    s_add_u32 m0, s38, 1024
    s_add_u32 s17, s17, 8192
    buffer_load_dwordx4 v30, s[68:71], s17 offen lds
    v_exp_f32 v67, v67
    v_exp_f32 v68, v68
    v_exp_f32 v69, v69
    v_exp_f32 v70, v70
    v_exp_f32 v71, v71
    v_cvt_pk_bf16_f32 v64, v64, v65
    v_mfma_f32_32x32x16_bf16 v[80:95], v[12:15], v[8:11], v[48:63]
    ds_read_b128 v[12:15], v24 offset:10240
    v_cvt_pk_bf16_f32 v65, v66, v67
    ds_write_b128 v185, v[248:251] offset:24576
    v_cvt_pk_bf16_f32 v66, v68, v69
    v_cvt_pk_bf16_f32 v67, v70, v71
    v_exp_f32 v72, v72
    v_exp_f32 v73, v73
    v_exp_f32 v74, v74
    s_waitcnt lgkmcnt(6)
    v_mfma_f32_32x32x16_bf16 v[96:111], v[16:19], v[64:67], v[96:111]
    v_exp_f32 v75, v75
    v_exp_f32 v76, v76
    v_exp_f32 v77, v77
    v_exp_f32 v78, v78
    v_exp_f32 v79, v79
    v_mfma_f32_32x32x16_bf16 v[192:207], v[136:139], v[148:151], v[192:207]
    v_cvt_pk_bf16_f32 v72, v72, v73
    v_cvt_pk_bf16_f32 v73, v74, v75
    v_cvt_pk_bf16_f32 v74, v76, v77
    v_cvt_pk_bf16_f32 v75, v78, v79
    v_exp_f32 v80, v80
    v_exp_f32 v81, v81
    s_waitcnt lgkmcnt(2)
    v_mfma_f32_32x32x16_bf16 v[96:111], v[20:23], v[72:75], v[96:111]
    v_exp_f32 v82, v82
    s_add_u32 m0, s21, 0
    s_add_u32 s17, s17, 8192
    buffer_load_dwordx4 v30, s[68:71], s17 offen lds
    v_exp_f32 v83, v83
    v_exp_f32 v84, v84
    v_exp_f32 v85, v85
    v_exp_f32 v86, v86
    v_exp_f32 v87, v87
    v_cvt_pk_bf16_f32 v80, v80, v81
    s_waitcnt lgkmcnt(1)
    v_mfma_f32_32x32x16_bf16 v[64:79], v[12:15], v[4:7], v[32:47]
    v_cvt_pk_bf16_f32 v81, v82, v83
    s_waitcnt vmcnt(4)
    ds_read_b64_tr_b16 v[128:129], v181 offset:0
    ds_read_b64_tr_b16 v[130:131], v181 offset:1024
    v_cvt_pk_bf16_f32 v82, v84, v85
    v_cvt_pk_bf16_f32 v83, v86, v87
    v_exp_f32 v88, v88
    v_exp_f32 v89, v89
    v_exp_f32 v90, v90
    v_mfma_f32_32x32x16_bf16 v[112:127], v[16:19], v[80:83], v[112:127]
    ds_read_b128 v[16:19], v25 offset:19584
    v_exp_f32 v91, v91
    ds_write_b128 v187, v[252:255] offset:52224
    v_exp_f32 v92, v92
    v_exp_f32 v93, v93
    v_exp_f32 v94, v94
    v_exp_f32 v95, v95
    v_mfma_f32_32x32x16_bf16 v[208:223], v[140:143], v[148:151], v[208:223]
    v_cvt_pk_bf16_f32 v88, v88, v89
    ds_read_b64_tr_b16 v[132:133], v181 offset:512
    ds_read_b64_tr_b16 v[134:135], v181 offset:1536
    v_cvt_pk_bf16_f32 v89, v90, v91
    buffer_load_dwordx4 v[144:147], v2, s[60:63], s18 offen offset:0 sc1
    v_cvt_pk_bf16_f32 v90, v92, v93
    v_cvt_pk_bf16_f32 v91, v94, v95
    v_exp_f32 v64, v64
    s_setprio 2
    v_exp_f32 v65, v65
    v_mfma_f32_32x32x16_bf16 v[112:127], v[20:23], v[88:91], v[112:127]
    ds_read_b128 v[20:23], v25 offset:20128
    v_exp_f32 v66, v66
    s_add_u32 m0, s21, 1024
    s_add_u32 s17, s17, 8192
    buffer_load_dwordx4 v30, s[68:71], s17 offen lds
    v_exp_f32 v67, v67
    v_exp_f32 v68, v68
    v_exp_f32 v69, v69
    v_exp_f32 v70, v70
    v_exp_f32 v71, v71
    v_cvt_pk_bf16_f32 v64, v64, v65
    v_mfma_f32_32x32x16_bf16 v[80:95], v[12:15], v[8:11], v[48:63]
    ds_read_b128 v[12:15], v24 offset:11264
    v_cvt_pk_bf16_f32 v65, v66, v67
    v_cvt_pk_bf16_f32 v66, v68, v69
    v_cvt_pk_bf16_f32 v67, v70, v71
    v_exp_f32 v72, v72
    v_exp_f32 v73, v73
    v_exp_f32 v74, v74
    s_waitcnt lgkmcnt(5)
    v_mfma_f32_32x32x16_bf16 v[96:111], v[16:19], v[64:67], v[96:111]
    v_exp_f32 v75, v75
    v_exp_f32 v76, v76
    v_exp_f32 v77, v77
    v_exp_f32 v78, v78
    v_exp_f32 v79, v79
    v_mfma_f32_32x32x16_bf16 v[192:207], v[128:131], v[152:155], v[192:207]
    v_cvt_pk_bf16_f32 v72, v72, v73
    v_cvt_pk_bf16_f32 v73, v74, v75
    v_cvt_pk_bf16_f32 v74, v76, v77
    v_cvt_pk_bf16_f32 v75, v78, v79
    v_exp_f32 v80, v80
    v_exp_f32 v81, v81
    s_waitcnt lgkmcnt(1)
    v_mfma_f32_32x32x16_bf16 v[96:111], v[20:23], v[72:75], v[96:111]
    v_exp_f32 v82, v82
    s_add_u32 m0, s16, 0
    s_add_u32 s17, s17, 8192
    buffer_load_dwordx4 v30, s[68:71], s17 offen lds
    v_exp_f32 v83, v83
    v_exp_f32 v84, v84
    v_exp_f32 v85, v85
    v_exp_f32 v86, v86
    v_exp_f32 v87, v87
    v_cvt_pk_bf16_f32 v80, v80, v81
    s_waitcnt lgkmcnt(0)
    v_mfma_f32_32x32x16_bf16 v[64:79], v[12:15], v[4:7], v[32:47]
    v_cvt_pk_bf16_f32 v81, v82, v83
    s_waitcnt vmcnt(4)
    ds_read_b64_tr_b16 v[136:137], v26 offset:0
    ds_read_b64_tr_b16 v[138:139], v26 offset:1024
    v_cvt_pk_bf16_f32 v82, v84, v85
    v_cvt_pk_bf16_f32 v83, v86, v87
    v_exp_f32 v88, v88
    v_exp_f32 v89, v89
    v_exp_f32 v90, v90
    v_mfma_f32_32x32x16_bf16 v[112:127], v[16:19], v[80:83], v[112:127]
    ds_read_b128 v[16:19], v25 offset:20672
    v_exp_f32 v91, v91
    v_exp_f32 v92, v92
    v_exp_f32 v93, v93
    v_exp_f32 v94, v94
    v_exp_f32 v95, v95
    v_mfma_f32_32x32x16_bf16 v[208:223], v[132:135], v[152:155], v[208:223]
    v_cvt_pk_bf16_f32 v88, v88, v89
    ds_read_b64_tr_b16 v[140:141], v26 offset:512
    ds_read_b64_tr_b16 v[142:143], v26 offset:1536
    v_cvt_pk_bf16_f32 v89, v90, v91
    buffer_load_dwordx4 v[148:151], v2, s[60:63], s18 offen offset:2048 sc1
    s_add_u32 s18, s18, 4096
    v_cvt_pk_bf16_f32 v90, v92, v93
    v_cvt_pk_bf16_f32 v91, v94, v95
    v_exp_f32 v64, v64
    v_exp_f32 v65, v65
    v_mfma_f32_32x32x16_bf16 v[112:127], v[20:23], v[88:91], v[112:127]
    ds_read_b128 v[20:23], v25 offset:21216
    v_exp_f32 v66, v66
    s_add_u32 m0, s16, 1024
    s_add_u32 s17, s17, 8192
    buffer_load_dwordx4 v30, s[68:71], s17 offen lds
    v_exp_f32 v67, v67
    v_exp_f32 v68, v68
    v_exp_f32 v69, v69
    v_exp_f32 v70, v70
    v_exp_f32 v71, v71
    v_cvt_pk_bf16_f32 v64, v64, v65
    v_mfma_f32_32x32x16_bf16 v[80:95], v[12:15], v[8:11], v[48:63]
    ds_read_b128 v[12:15], v24 offset:12288
    v_cvt_pk_bf16_f32 v65, v66, v67
    v_cvt_pk_bf16_f32 v66, v68, v69
    v_cvt_pk_bf16_f32 v67, v70, v71
    v_exp_f32 v72, v72
    v_exp_f32 v73, v73
    v_exp_f32 v74, v74
    s_waitcnt lgkmcnt(4)
    v_mfma_f32_32x32x16_bf16 v[96:111], v[16:19], v[64:67], v[96:111]
    v_exp_f32 v75, v75
    v_exp_f32 v76, v76
    v_exp_f32 v77, v77
    v_exp_f32 v78, v78
    v_exp_f32 v79, v79
    v_mfma_f32_32x32x16_bf16 v[192:207], v[136:139], v[156:159], v[192:207]
    v_cvt_pk_bf16_f32 v72, v72, v73
    v_cvt_pk_bf16_f32 v73, v74, v75
    v_cvt_pk_bf16_f32 v74, v76, v77
    v_cvt_pk_bf16_f32 v75, v78, v79
    v_exp_f32 v80, v80
    v_exp_f32 v81, v81
    s_waitcnt lgkmcnt(1)
    v_mfma_f32_32x32x16_bf16 v[96:111], v[20:23], v[72:75], v[96:111]
    v_exp_f32 v82, v82
    s_add_u32 m0, s38, 0
    s_add_u32 s17, s17, 8192
    buffer_load_dwordx4 v30, s[68:71], s17 offen lds
    v_exp_f32 v83, v83
    v_exp_f32 v84, v84
    v_exp_f32 v85, v85
    v_exp_f32 v86, v86
    v_exp_f32 v87, v87
    v_cvt_pk_bf16_f32 v80, v80, v81
    s_waitcnt lgkmcnt(0)
    v_mfma_f32_32x32x16_bf16 v[64:79], v[12:15], v[4:7], v[32:47]
    v_cvt_pk_bf16_f32 v81, v82, v83
    s_waitcnt vmcnt(4)
    ds_read_b64_tr_b16 v[128:129], v27 offset:0
    ds_read_b64_tr_b16 v[130:131], v27 offset:1024
    v_cvt_pk_bf16_f32 v82, v84, v85
    v_cvt_pk_bf16_f32 v83, v86, v87
    v_exp_f32 v88, v88
    v_exp_f32 v89, v89
    v_exp_f32 v90, v90
    v_mfma_f32_32x32x16_bf16 v[112:127], v[16:19], v[80:83], v[112:127]
    ds_read_b128 v[16:19], v25 offset:21760
    v_exp_f32 v91, v91
    v_exp_f32 v92, v92
    v_exp_f32 v93, v93
    v_exp_f32 v94, v94
    v_exp_f32 v95, v95
    v_mfma_f32_32x32x16_bf16 v[208:223], v[140:143], v[156:159], v[208:223]
    v_cvt_pk_bf16_f32 v88, v88, v89
    ds_read_b64_tr_b16 v[132:133], v27 offset:512
    ds_read_b64_tr_b16 v[134:135], v27 offset:1536
    v_cvt_pk_bf16_f32 v89, v90, v91
    buffer_load_dwordx4 v[152:155], v2, s[60:63], s18 offen offset:0 sc1
    v_cvt_pk_bf16_f32 v90, v92, v93
    v_cvt_pk_bf16_f32 v91, v94, v95
    v_exp_f32 v64, v64
    s_setprio 1
    v_exp_f32 v65, v65
    v_mfma_f32_32x32x16_bf16 v[112:127], v[20:23], v[88:91], v[112:127]
    ds_read_b128 v[20:23], v25 offset:22304
    v_exp_f32 v66, v66
    s_add_u32 m0, s38, 1024
    s_add_u32 s17, s17, 8192
    buffer_load_dwordx4 v30, s[68:71], s17 offen lds
    v_exp_f32 v67, v67
    v_exp_f32 v68, v68
    v_exp_f32 v69, v69
    v_exp_f32 v70, v70
    v_exp_f32 v71, v71
    v_cvt_pk_bf16_f32 v64, v64, v65
    v_mfma_f32_32x32x16_bf16 v[80:95], v[12:15], v[8:11], v[48:63]
    ds_read_b128 v[12:15], v24 offset:13312
    v_cvt_pk_bf16_f32 v65, v66, v67
    v_cvt_pk_bf16_f32 v66, v68, v69
    v_cvt_pk_bf16_f32 v67, v70, v71
    v_exp_f32 v72, v72
    v_exp_f32 v73, v73
    v_exp_f32 v74, v74
    s_waitcnt lgkmcnt(4)
    v_mfma_f32_32x32x16_bf16 v[96:111], v[16:19], v[64:67], v[96:111]
    v_exp_f32 v75, v75
    v_exp_f32 v76, v76
    v_exp_f32 v77, v77
    v_exp_f32 v78, v78
    v_exp_f32 v79, v79
    v_mfma_f32_32x32x16_bf16 v[192:207], v[128:131], v[144:147], v[192:207]
    v_cvt_pk_bf16_f32 v72, v72, v73
    v_cvt_pk_bf16_f32 v73, v74, v75
    v_cvt_pk_bf16_f32 v74, v76, v77
    v_cvt_pk_bf16_f32 v75, v78, v79
    v_exp_f32 v80, v80
    v_exp_f32 v81, v81
    s_waitcnt lgkmcnt(1)
    v_mfma_f32_32x32x16_bf16 v[96:111], v[20:23], v[72:75], v[96:111]
    v_exp_f32 v82, v82
    s_add_u32 m0, s21, 0
    s_add_u32 s17, s17, 8192
    buffer_load_dwordx4 v30, s[68:71], s17 offen lds
    v_exp_f32 v83, v83
    v_exp_f32 v84, v84
    v_exp_f32 v85, v85
    v_exp_f32 v86, v86
    v_exp_f32 v87, v87
    v_cvt_pk_bf16_f32 v80, v80, v81
    s_waitcnt lgkmcnt(0)
    v_mfma_f32_32x32x16_bf16 v[64:79], v[12:15], v[4:7], v[32:47]
    v_cvt_pk_bf16_f32 v81, v82, v83
    s_waitcnt vmcnt(4)
    ds_read_b64_tr_b16 v[136:137], v181 offset:0
    ds_read_b64_tr_b16 v[138:139], v181 offset:1024
    v_cvt_pk_bf16_f32 v82, v84, v85
    v_cvt_pk_bf16_f32 v83, v86, v87
    v_exp_f32 v88, v88
    v_exp_f32 v89, v89
    v_exp_f32 v90, v90
    v_mfma_f32_32x32x16_bf16 v[112:127], v[16:19], v[80:83], v[112:127]
    ds_read_b128 v[16:19], v25 offset:22848
    v_exp_f32 v91, v91
    v_exp_f32 v92, v92
    v_exp_f32 v93, v93
    v_exp_f32 v94, v94
    v_exp_f32 v95, v95
    v_mfma_f32_32x32x16_bf16 v[208:223], v[132:135], v[144:147], v[208:223]
    v_cvt_pk_bf16_f32 v88, v88, v89
    ds_read_b64_tr_b16 v[140:141], v181 offset:512
    ds_read_b64_tr_b16 v[142:143], v181 offset:1536
    v_cvt_pk_bf16_f32 v89, v90, v91
    buffer_load_dwordx4 v[156:159], v2, s[60:63], s18 offen offset:2048 sc1
    s_add_u32 s18, s18, 4096
    v_cvt_pk_bf16_f32 v90, v92, v93
    v_cvt_pk_bf16_f32 v91, v94, v95
    v_exp_f32 v64, v64
    v_exp_f32 v65, v65
    v_mfma_f32_32x32x16_bf16 v[112:127], v[20:23], v[88:91], v[112:127]
    ds_read_b128 v[20:23], v25 offset:23392
    v_exp_f32 v66, v66
    s_add_u32 m0, s21, 1024
    s_add_u32 s17, s17, 8192
    buffer_load_dwordx4 v30, s[68:71], s17 offen lds
    v_exp_f32 v67, v67
    v_exp_f32 v68, v68
    v_exp_f32 v69, v69
    v_exp_f32 v70, v70
    v_exp_f32 v71, v71
    v_cvt_pk_bf16_f32 v64, v64, v65
    v_mfma_f32_32x32x16_bf16 v[80:95], v[12:15], v[8:11], v[48:63]
    ds_read_b128 v[12:15], v24 offset:14336
    v_cvt_pk_bf16_f32 v65, v66, v67
    v_cvt_pk_bf16_f32 v66, v68, v69
    v_cvt_pk_bf16_f32 v67, v70, v71
    v_exp_f32 v72, v72
    v_exp_f32 v73, v73
    v_exp_f32 v74, v74
    s_waitcnt lgkmcnt(4)
    v_mfma_f32_32x32x16_bf16 v[96:111], v[16:19], v[64:67], v[96:111]
    v_exp_f32 v75, v75
    v_exp_f32 v76, v76
    v_exp_f32 v77, v77
    v_exp_f32 v78, v78
    v_exp_f32 v79, v79
    v_mfma_f32_32x32x16_bf16 v[192:207], v[136:139], v[148:151], v[192:207]
    v_cvt_pk_bf16_f32 v72, v72, v73
    v_cvt_pk_bf16_f32 v73, v74, v75
    v_cvt_pk_bf16_f32 v74, v76, v77
    v_cvt_pk_bf16_f32 v75, v78, v79
    v_exp_f32 v80, v80
    v_exp_f32 v81, v81
    s_waitcnt lgkmcnt(1)
    v_mfma_f32_32x32x16_bf16 v[96:111], v[20:23], v[72:75], v[96:111]
    v_exp_f32 v82, v82
    s_add_u32 m0, s16, 0
    s_add_u32 s17, s17, 8192
    buffer_load_dwordx4 v30, s[68:71], s17 offen lds
    v_exp_f32 v83, v83
    v_exp_f32 v84, v84
    v_exp_f32 v85, v85
    v_exp_f32 v86, v86
    v_exp_f32 v87, v87
    v_cvt_pk_bf16_f32 v80, v80, v81
    s_waitcnt lgkmcnt(0)
    v_mfma_f32_32x32x16_bf16 v[64:79], v[12:15], v[4:7], v[32:47]
    v_cvt_pk_bf16_f32 v81, v82, v83
    s_waitcnt vmcnt(4)
    ds_read_b64_tr_b16 v[128:129], v26 offset:0
    ds_read_b64_tr_b16 v[130:131], v26 offset:1024
    v_cvt_pk_bf16_f32 v82, v84, v85
    v_cvt_pk_bf16_f32 v83, v86, v87
    v_exp_f32 v88, v88
    v_exp_f32 v89, v89
    v_exp_f32 v90, v90
    v_mfma_f32_32x32x16_bf16 v[112:127], v[16:19], v[80:83], v[112:127]
    ds_read_b128 v[16:19], v25 offset:23936
    v_exp_f32 v91, v91
    v_exp_f32 v92, v92
    v_exp_f32 v93, v93
    v_exp_f32 v94, v94
    v_exp_f32 v95, v95
    v_mfma_f32_32x32x16_bf16 v[208:223], v[140:143], v[148:151], v[208:223]
    v_cvt_pk_bf16_f32 v88, v88, v89
    ds_read_b64_tr_b16 v[132:133], v26 offset:512
    ds_read_b64_tr_b16 v[134:135], v26 offset:1536
    v_cvt_pk_bf16_f32 v89, v90, v91
    buffer_load_dwordx4 v[144:147], v2, s[60:63], s18 offen offset:0 sc1
    v_cvt_pk_bf16_f32 v90, v92, v93
    v_cvt_pk_bf16_f32 v91, v94, v95
    v_exp_f32 v64, v64
    s_setprio 0
    v_exp_f32 v65, v65
    v_mfma_f32_32x32x16_bf16 v[112:127], v[20:23], v[88:91], v[112:127]
    ds_read_b128 v[20:23], v25 offset:24480
    v_exp_f32 v66, v66
    s_add_u32 m0, s16, 1024
    s_add_u32 s17, s17, 8192
    buffer_load_dwordx4 v30, s[68:71], s17 offen lds
    v_exp_f32 v67, v67
    v_exp_f32 v68, v68
    v_exp_f32 v69, v69
    v_exp_f32 v70, v70
    v_exp_f32 v71, v71
    v_cvt_pk_bf16_f32 v64, v64, v65
    v_mfma_f32_32x32x16_bf16 v[80:95], v[12:15], v[8:11], v[48:63]
    ds_read_b128 v[12:15], v24 offset:15360
    v_cvt_pk_bf16_f32 v65, v66, v67
    v_cvt_pk_bf16_f32 v66, v68, v69
    v_cvt_pk_bf16_f32 v67, v70, v71
    v_exp_f32 v72, v72
    v_exp_f32 v73, v73
    v_exp_f32 v74, v74
    s_waitcnt lgkmcnt(4)
    v_mfma_f32_32x32x16_bf16 v[96:111], v[16:19], v[64:67], v[96:111]
    v_exp_f32 v75, v75
    v_exp_f32 v76, v76
    v_exp_f32 v77, v77
    v_exp_f32 v78, v78
    v_exp_f32 v79, v79
    v_mfma_f32_32x32x16_bf16 v[192:207], v[128:131], v[152:155], v[192:207]
    v_cvt_pk_bf16_f32 v72, v72, v73
    v_cvt_pk_bf16_f32 v73, v74, v75
    v_cvt_pk_bf16_f32 v74, v76, v77
    v_cvt_pk_bf16_f32 v75, v78, v79
    v_exp_f32 v80, v80
    v_exp_f32 v81, v81
    s_waitcnt lgkmcnt(1)
    v_mfma_f32_32x32x16_bf16 v[96:111], v[20:23], v[72:75], v[96:111]
    v_exp_f32 v82, v82
    s_add_u32 m0, s38, 0
    s_add_u32 s17, s17, 8192
    buffer_load_dwordx4 v30, s[68:71], s17 offen lds
    v_exp_f32 v83, v83
    v_exp_f32 v84, v84
    v_exp_f32 v85, v85
    v_exp_f32 v86, v86
    v_exp_f32 v87, v87
    v_cvt_pk_bf16_f32 v80, v80, v81
    s_waitcnt lgkmcnt(0)
    v_mfma_f32_32x32x16_bf16 v[64:79], v[12:15], v[4:7], v[32:47]
    v_cvt_pk_bf16_f32 v81, v82, v83
    s_waitcnt vmcnt(4)
    ds_read_b64_tr_b16 v[136:137], v27 offset:0
    ds_read_b64_tr_b16 v[138:139], v27 offset:1024
    v_cvt_pk_bf16_f32 v82, v84, v85
    v_cvt_pk_bf16_f32 v83, v86, v87
    v_exp_f32 v88, v88
    v_exp_f32 v89, v89
    v_exp_f32 v90, v90
    v_mfma_f32_32x32x16_bf16 v[112:127], v[16:19], v[80:83], v[112:127]
    ds_read_b128 v[16:19], v25 offset:25024
    v_exp_f32 v91, v91
    v_exp_f32 v92, v92
    v_exp_f32 v93, v93
    v_exp_f32 v94, v94
    v_exp_f32 v95, v95
    v_mfma_f32_32x32x16_bf16 v[208:223], v[132:135], v[152:155], v[208:223]
    v_cvt_pk_bf16_f32 v88, v88, v89
    ds_read_b64_tr_b16 v[140:141], v27 offset:512
    ds_read_b64_tr_b16 v[142:143], v27 offset:1536
    v_cvt_pk_bf16_f32 v89, v90, v91
    buffer_load_dwordx4 v[148:151], v2, s[60:63], s18 offen offset:2048 sc1
    s_add_u32 s18, s18, 4096
    v_cvt_pk_bf16_f32 v90, v92, v93
    v_cvt_pk_bf16_f32 v91, v94, v95
    v_exp_f32 v64, v64
    v_exp_f32 v65, v65
    v_mfma_f32_32x32x16_bf16 v[112:127], v[20:23], v[88:91], v[112:127]
    ds_read_b128 v[20:23], v25 offset:25568
    v_exp_f32 v66, v66
    s_add_u32 m0, s38, 1024
    s_add_u32 s17, s17, 8192
    buffer_load_dwordx4 v30, s[68:71], s17 offen lds
    v_exp_f32 v67, v67
    v_exp_f32 v68, v68
    v_exp_f32 v69, v69
    v_exp_f32 v70, v70
    v_exp_f32 v71, v71
    s_waitcnt lgkmcnt(0)
    s_barrier
    v_cvt_pk_bf16_f32 v64, v64, v65
    v_mfma_f32_32x32x16_bf16 v[80:95], v[12:15], v[8:11], v[48:63]
    ds_read_b128 v[12:15], v24 offset:16384
    v_cvt_pk_bf16_f32 v65, v66, v67
    v_cvt_pk_bf16_f32 v66, v68, v69
    v_cvt_pk_bf16_f32 v67, v70, v71
    v_exp_f32 v72, v72
    v_exp_f32 v73, v73
    v_exp_f32 v74, v74
    v_mfma_f32_32x32x16_bf16 v[96:111], v[16:19], v[64:67], v[96:111]
    v_exp_f32 v75, v75
    v_exp_f32 v76, v76
    v_exp_f32 v77, v77
    v_exp_f32 v78, v78
    v_exp_f32 v79, v79
    v_mfma_f32_32x32x16_bf16 v[192:207], v[136:139], v[156:159], v[192:207]
    v_cvt_pk_bf16_f32 v72, v72, v73
    v_cvt_pk_bf16_f32 v73, v74, v75
    v_cvt_pk_bf16_f32 v74, v76, v77
    v_cvt_pk_bf16_f32 v75, v78, v79
    v_exp_f32 v80, v80
    v_exp_f32 v81, v81
    v_mfma_f32_32x32x16_bf16 v[96:111], v[20:23], v[72:75], v[96:111]
    v_exp_f32 v82, v82
    s_add_u32 m0, s21, 0
    s_add_u32 s17, s17, 8192
    buffer_load_dwordx4 v30, s[68:71], s17 offen lds
    v_exp_f32 v83, v83
    v_exp_f32 v84, v84
    v_exp_f32 v85, v85
    v_exp_f32 v86, v86
    v_exp_f32 v87, v87
    v_cvt_pk_bf16_f32 v80, v80, v81
    s_waitcnt lgkmcnt(0)
    v_mfma_f32_32x32x16_bf16 v[64:79], v[12:15], v[4:7], v[32:47]
    v_cvt_pk_bf16_f32 v81, v82, v83
    s_waitcnt vmcnt(4)
    ds_read_b64_tr_b16 v[128:129], v181 offset:0
    ds_read_b64_tr_b16 v[130:131], v181 offset:1024
    v_cvt_pk_bf16_f32 v82, v84, v85
    v_cvt_pk_bf16_f32 v83, v86, v87
    v_exp_f32 v88, v88
    v_exp_f32 v89, v89
    v_exp_f32 v90, v90
    v_mfma_f32_32x32x16_bf16 v[112:127], v[16:19], v[80:83], v[112:127]
    ds_read_b128 v[16:19], v25 offset:34816
    v_exp_f32 v91, v91
    v_exp_f32 v92, v92
    v_exp_f32 v93, v93
    v_exp_f32 v94, v94
    v_exp_f32 v95, v95
    v_mfma_f32_32x32x16_bf16 v[208:223], v[140:143], v[156:159], v[208:223]
    v_cvt_pk_bf16_f32 v88, v88, v89
    ds_read_b64_tr_b16 v[132:133], v181 offset:512
    ds_read_b64_tr_b16 v[134:135], v181 offset:1536
    v_cvt_pk_bf16_f32 v89, v90, v91
    buffer_load_dwordx4 v[152:155], v2, s[60:63], s18 offen offset:0 sc1
    v_cvt_pk_bf16_f32 v90, v92, v93
    v_cvt_pk_bf16_f32 v91, v94, v95
    v_exp_f32 v64, v64
    s_setprio 3
    v_exp_f32 v65, v65
    v_mfma_f32_32x32x16_bf16 v[112:127], v[20:23], v[88:91], v[112:127]
    ds_read_b128 v[20:23], v25 offset:35360
    v_exp_f32 v66, v66
    s_add_u32 m0, s21, 1024
    s_add_u32 s17, s17, 8192
    buffer_load_dwordx4 v30, s[68:71], s17 offen lds
    v_exp_f32 v67, v67
    v_exp_f32 v68, v68
    v_exp_f32 v69, v69
    v_exp_f32 v70, v70
    v_exp_f32 v71, v71
    v_cvt_pk_bf16_f32 v64, v64, v65
    v_mfma_f32_32x32x16_bf16 v[80:95], v[12:15], v[8:11], v[48:63]
    ds_read_b128 v[12:15], v24 offset:17408
    v_cvt_pk_bf16_f32 v65, v66, v67
    v_cvt_pk_bf16_f32 v66, v68, v69
    v_cvt_pk_bf16_f32 v67, v70, v71
    v_exp_f32 v72, v72
    v_exp_f32 v73, v73
    v_exp_f32 v74, v74
    s_waitcnt lgkmcnt(4)
    v_mfma_f32_32x32x16_bf16 v[96:111], v[16:19], v[64:67], v[96:111]
    v_exp_f32 v75, v75
    v_exp_f32 v76, v76
    v_exp_f32 v77, v77
    v_exp_f32 v78, v78
    v_exp_f32 v79, v79
    v_mfma_f32_32x32x16_bf16 v[192:207], v[128:131], v[144:147], v[192:207]
    v_cvt_pk_bf16_f32 v72, v72, v73
    v_cvt_pk_bf16_f32 v73, v74, v75
    v_cvt_pk_bf16_f32 v74, v76, v77
    v_cvt_pk_bf16_f32 v75, v78, v79
    v_exp_f32 v80, v80
    v_exp_f32 v81, v81
    s_waitcnt lgkmcnt(1)
    v_mfma_f32_32x32x16_bf16 v[96:111], v[20:23], v[72:75], v[96:111]
    v_exp_f32 v82, v82
    s_add_u32 m0, s16, 0
    s_add_u32 s17, s17, 8192
    buffer_load_dwordx4 v30, s[68:71], s17 offen lds
    v_exp_f32 v83, v83
    v_exp_f32 v84, v84
    v_exp_f32 v85, v85
    v_exp_f32 v86, v86
    v_exp_f32 v87, v87
    v_cvt_pk_bf16_f32 v80, v80, v81
    s_waitcnt lgkmcnt(0)
    v_mfma_f32_32x32x16_bf16 v[64:79], v[12:15], v[4:7], v[32:47]
    v_cvt_pk_bf16_f32 v81, v82, v83
    s_waitcnt vmcnt(4)
    ds_read_b64_tr_b16 v[136:137], v26 offset:0
    ds_read_b64_tr_b16 v[138:139], v26 offset:1024
    v_cvt_pk_bf16_f32 v82, v84, v85
    v_cvt_pk_bf16_f32 v83, v86, v87
    v_exp_f32 v88, v88
    v_exp_f32 v89, v89
    v_exp_f32 v90, v90
    v_mfma_f32_32x32x16_bf16 v[112:127], v[16:19], v[80:83], v[112:127]
    ds_read_b128 v[16:19], v25 offset:35904
    v_exp_f32 v91, v91
    v_exp_f32 v92, v92
    v_exp_f32 v93, v93
    v_exp_f32 v94, v94
    v_exp_f32 v95, v95
    v_mfma_f32_32x32x16_bf16 v[208:223], v[132:135], v[144:147], v[208:223]
    v_cvt_pk_bf16_f32 v88, v88, v89
    ds_read_b64_tr_b16 v[140:141], v26 offset:512
    ds_read_b64_tr_b16 v[142:143], v26 offset:1536
    v_cvt_pk_bf16_f32 v89, v90, v91
    buffer_load_dwordx4 v[156:159], v2, s[60:63], s18 offen offset:2048 sc1
    s_add_u32 s18, s18, 4096
    v_cvt_pk_bf16_f32 v90, v92, v93
    v_cvt_pk_bf16_f32 v91, v94, v95
    v_exp_f32 v64, v64
    v_exp_f32 v65, v65
    v_mfma_f32_32x32x16_bf16 v[112:127], v[20:23], v[88:91], v[112:127]
    ds_read_b128 v[20:23], v25 offset:36448
    v_exp_f32 v66, v66
    s_add_u32 m0, s16, 1024
    s_add_u32 s17, s17, 8192
    buffer_load_dwordx4 v30, s[68:71], s17 offen lds
    v_exp_f32 v67, v67
    v_exp_f32 v68, v68
    v_exp_f32 v69, v69
    v_exp_f32 v70, v70
    v_exp_f32 v71, v71
    v_cvt_pk_bf16_f32 v64, v64, v65
    v_mfma_f32_32x32x16_bf16 v[80:95], v[12:15], v[8:11], v[48:63]
    ds_read_b128 v[12:15], v24 offset:18432
    v_cvt_pk_bf16_f32 v65, v66, v67
    v_cvt_pk_bf16_f32 v66, v68, v69
    v_cvt_pk_bf16_f32 v67, v70, v71
    v_exp_f32 v72, v72
    v_exp_f32 v73, v73
    v_exp_f32 v74, v74
    s_waitcnt lgkmcnt(4)
    v_mfma_f32_32x32x16_bf16 v[96:111], v[16:19], v[64:67], v[96:111]
    v_exp_f32 v75, v75
    v_exp_f32 v76, v76
    v_exp_f32 v77, v77
    v_exp_f32 v78, v78
    v_exp_f32 v79, v79
    v_mfma_f32_32x32x16_bf16 v[192:207], v[136:139], v[148:151], v[192:207]
    v_cvt_pk_bf16_f32 v72, v72, v73
    v_cvt_pk_bf16_f32 v73, v74, v75
    v_cvt_pk_bf16_f32 v74, v76, v77
    v_cvt_pk_bf16_f32 v75, v78, v79
    v_exp_f32 v80, v80
    v_exp_f32 v81, v81
    s_waitcnt lgkmcnt(1)
    v_mfma_f32_32x32x16_bf16 v[96:111], v[20:23], v[72:75], v[96:111]
    v_exp_f32 v82, v82
    s_add_u32 m0, s38, 0
    s_add_u32 s17, s17, 8192
    buffer_load_dwordx4 v30, s[68:71], s17 offen lds
    v_exp_f32 v83, v83
    v_exp_f32 v84, v84
    v_exp_f32 v85, v85
    v_exp_f32 v86, v86
    v_exp_f32 v87, v87
    v_cvt_pk_bf16_f32 v80, v80, v81
    s_waitcnt lgkmcnt(0)
    v_mfma_f32_32x32x16_bf16 v[64:79], v[12:15], v[4:7], v[32:47]
    v_cvt_pk_bf16_f32 v81, v82, v83
    s_waitcnt vmcnt(4)
    ds_read_b64_tr_b16 v[128:129], v27 offset:0
    ds_read_b64_tr_b16 v[130:131], v27 offset:1024
    v_cvt_pk_bf16_f32 v82, v84, v85
    v_cvt_pk_bf16_f32 v83, v86, v87
    v_exp_f32 v88, v88
    v_exp_f32 v89, v89
    v_exp_f32 v90, v90
    v_mfma_f32_32x32x16_bf16 v[112:127], v[16:19], v[80:83], v[112:127]
    ds_read_b128 v[16:19], v25 offset:36992
    v_exp_f32 v91, v91
    v_exp_f32 v92, v92
    v_exp_f32 v93, v93
    v_exp_f32 v94, v94
    v_exp_f32 v95, v95
    v_mfma_f32_32x32x16_bf16 v[208:223], v[140:143], v[148:151], v[208:223]
    v_cvt_pk_bf16_f32 v88, v88, v89
    ds_read_b64_tr_b16 v[132:133], v27 offset:512
    ds_read_b64_tr_b16 v[134:135], v27 offset:1536
    v_cvt_pk_bf16_f32 v89, v90, v91
    buffer_load_dwordx4 v[144:147], v2, s[60:63], s18 offen offset:0 sc1
    v_cvt_pk_bf16_f32 v90, v92, v93
    v_cvt_pk_bf16_f32 v91, v94, v95
    v_exp_f32 v64, v64
    s_setprio 2
    v_exp_f32 v65, v65
    v_mfma_f32_32x32x16_bf16 v[112:127], v[20:23], v[88:91], v[112:127]
    ds_read_b128 v[20:23], v25 offset:37536
    v_exp_f32 v66, v66
    s_add_u32 m0, s38, 1024
    s_add_u32 s17, s17, 8192
    buffer_load_dwordx4 v30, s[68:71], s17 offen lds
    v_exp_f32 v67, v67
    v_exp_f32 v68, v68
    v_exp_f32 v69, v69
    v_exp_f32 v70, v70
    v_exp_f32 v71, v71
    v_cvt_pk_bf16_f32 v64, v64, v65
    v_mfma_f32_32x32x16_bf16 v[80:95], v[12:15], v[8:11], v[48:63]
    ds_read_b128 v[12:15], v24 offset:19456
    v_cvt_pk_bf16_f32 v65, v66, v67
    v_cvt_pk_bf16_f32 v66, v68, v69
    v_cvt_pk_bf16_f32 v67, v70, v71
    v_exp_f32 v72, v72
    v_exp_f32 v73, v73
    v_exp_f32 v74, v74
    s_waitcnt lgkmcnt(4)
    v_mfma_f32_32x32x16_bf16 v[96:111], v[16:19], v[64:67], v[96:111]
    v_exp_f32 v75, v75
    v_exp_f32 v76, v76
    v_exp_f32 v77, v77
    v_exp_f32 v78, v78
    v_exp_f32 v79, v79
    v_mfma_f32_32x32x16_bf16 v[192:207], v[128:131], v[152:155], v[192:207]
    v_cvt_pk_bf16_f32 v72, v72, v73
    v_cvt_pk_bf16_f32 v73, v74, v75
    v_cvt_pk_bf16_f32 v74, v76, v77
    v_cvt_pk_bf16_f32 v75, v78, v79
    v_exp_f32 v80, v80
    v_exp_f32 v81, v81
    s_waitcnt lgkmcnt(1)
    v_mfma_f32_32x32x16_bf16 v[96:111], v[20:23], v[72:75], v[96:111]
    v_exp_f32 v82, v82
    s_add_u32 m0, s21, 0
    s_add_u32 s17, s17, 8192
    buffer_load_dwordx4 v30, s[68:71], s17 offen lds
    v_exp_f32 v83, v83
    v_exp_f32 v84, v84
    v_exp_f32 v85, v85
    v_exp_f32 v86, v86
    v_exp_f32 v87, v87
    v_cvt_pk_bf16_f32 v80, v80, v81
    s_waitcnt lgkmcnt(0)
    v_mfma_f32_32x32x16_bf16 v[64:79], v[12:15], v[4:7], v[32:47]
    v_cvt_pk_bf16_f32 v81, v82, v83
    s_waitcnt vmcnt(4)
    ds_read_b64_tr_b16 v[136:137], v181 offset:0
    ds_read_b64_tr_b16 v[138:139], v181 offset:1024
    v_cvt_pk_bf16_f32 v82, v84, v85
    v_cvt_pk_bf16_f32 v83, v86, v87
    v_exp_f32 v88, v88
    v_exp_f32 v89, v89
    v_exp_f32 v90, v90
    v_mfma_f32_32x32x16_bf16 v[112:127], v[16:19], v[80:83], v[112:127]
    ds_read_b128 v[16:19], v25 offset:38080
    v_exp_f32 v91, v91
    v_exp_f32 v92, v92
    v_exp_f32 v93, v93
    v_exp_f32 v94, v94
    v_exp_f32 v95, v95
    v_mfma_f32_32x32x16_bf16 v[208:223], v[132:135], v[152:155], v[208:223]
    v_cvt_pk_bf16_f32 v88, v88, v89
    ds_read_b64_tr_b16 v[140:141], v181 offset:512
    ds_read_b64_tr_b16 v[142:143], v181 offset:1536
    v_cvt_pk_bf16_f32 v89, v90, v91
    buffer_load_dwordx4 v[148:151], v2, s[60:63], s18 offen offset:2048 sc1
    s_add_u32 s18, s18, 4096
    v_cvt_pk_bf16_f32 v90, v92, v93
    v_cvt_pk_bf16_f32 v91, v94, v95
    v_exp_f32 v64, v64
    v_exp_f32 v65, v65
    v_mfma_f32_32x32x16_bf16 v[112:127], v[20:23], v[88:91], v[112:127]
    ds_read_b128 v[20:23], v25 offset:38624
    v_exp_f32 v66, v66
    s_add_u32 m0, s21, 1024
    s_add_u32 s17, s17, 8192
    buffer_load_dwordx4 v30, s[68:71], s17 offen lds
    v_exp_f32 v67, v67
    v_exp_f32 v68, v68
    v_exp_f32 v69, v69
    v_exp_f32 v70, v70
    v_exp_f32 v71, v71
    v_cvt_pk_bf16_f32 v64, v64, v65
    v_mfma_f32_32x32x16_bf16 v[80:95], v[12:15], v[8:11], v[48:63]
    ds_read_b128 v[12:15], v24 offset:20480
    v_cvt_pk_bf16_f32 v65, v66, v67
    v_cvt_pk_bf16_f32 v66, v68, v69
    v_cvt_pk_bf16_f32 v67, v70, v71
    v_exp_f32 v72, v72
    v_exp_f32 v73, v73
    v_exp_f32 v74, v74
    s_waitcnt lgkmcnt(4)
    v_mfma_f32_32x32x16_bf16 v[96:111], v[16:19], v[64:67], v[96:111]
    v_exp_f32 v75, v75
    v_exp_f32 v76, v76
    v_exp_f32 v77, v77
    v_exp_f32 v78, v78
    v_exp_f32 v79, v79
    v_mfma_f32_32x32x16_bf16 v[192:207], v[136:139], v[156:159], v[192:207]
    v_cvt_pk_bf16_f32 v72, v72, v73
    v_cvt_pk_bf16_f32 v73, v74, v75
    v_cvt_pk_bf16_f32 v74, v76, v77
    v_cvt_pk_bf16_f32 v75, v78, v79
    v_exp_f32 v80, v80
    v_exp_f32 v81, v81
    s_waitcnt lgkmcnt(1)
    v_mfma_f32_32x32x16_bf16 v[96:111], v[20:23], v[72:75], v[96:111]
    v_exp_f32 v82, v82
    s_add_u32 m0, s16, 0
    s_add_u32 s17, s17, 8192
    buffer_load_dwordx4 v30, s[68:71], s17 offen lds
    v_exp_f32 v83, v83
    v_exp_f32 v84, v84
    v_exp_f32 v85, v85
    v_exp_f32 v86, v86
    v_exp_f32 v87, v87
    v_cvt_pk_bf16_f32 v80, v80, v81
    s_waitcnt lgkmcnt(0)
    v_mfma_f32_32x32x16_bf16 v[64:79], v[12:15], v[4:7], v[32:47]
    v_cvt_pk_bf16_f32 v81, v82, v83
    s_waitcnt vmcnt(4)
    ds_read_b64_tr_b16 v[128:129], v26 offset:0
    ds_read_b64_tr_b16 v[130:131], v26 offset:1024
    v_cvt_pk_bf16_f32 v82, v84, v85
    v_cvt_pk_bf16_f32 v83, v86, v87
    v_exp_f32 v88, v88
    v_exp_f32 v89, v89
    v_exp_f32 v90, v90
    v_mfma_f32_32x32x16_bf16 v[112:127], v[16:19], v[80:83], v[112:127]
    ds_read_b128 v[16:19], v25 offset:39168
    v_exp_f32 v91, v91
    v_exp_f32 v92, v92
    v_exp_f32 v93, v93
    v_exp_f32 v94, v94
    v_exp_f32 v95, v95
    v_mfma_f32_32x32x16_bf16 v[208:223], v[140:143], v[156:159], v[208:223]
    v_cvt_pk_bf16_f32 v88, v88, v89
    ds_read_b64_tr_b16 v[132:133], v26 offset:512
    ds_read_b64_tr_b16 v[134:135], v26 offset:1536
    v_cvt_pk_bf16_f32 v89, v90, v91
    buffer_load_dwordx4 v[152:155], v2, s[60:63], s18 offen offset:0 sc1
    v_cvt_pk_bf16_f32 v90, v92, v93
    v_cvt_pk_bf16_f32 v91, v94, v95
    v_exp_f32 v64, v64
    s_setprio 1
    v_exp_f32 v65, v65
    v_mfma_f32_32x32x16_bf16 v[112:127], v[20:23], v[88:91], v[112:127]
    ds_read_b128 v[20:23], v25 offset:39712
    v_exp_f32 v66, v66
    s_add_u32 m0, s16, 1024
    s_add_u32 s17, s17, 8192
    buffer_load_dwordx4 v30, s[68:71], s17 offen lds
    v_exp_f32 v67, v67
    v_exp_f32 v68, v68
    v_exp_f32 v69, v69
    v_exp_f32 v70, v70
    v_exp_f32 v71, v71
    v_cvt_pk_bf16_f32 v64, v64, v65
    v_mfma_f32_32x32x16_bf16 v[80:95], v[12:15], v[8:11], v[48:63]
    ds_read_b128 v[12:15], v24 offset:21504
    v_cvt_pk_bf16_f32 v65, v66, v67
    v_cvt_pk_bf16_f32 v66, v68, v69
    v_cvt_pk_bf16_f32 v67, v70, v71
    v_exp_f32 v72, v72
    v_exp_f32 v73, v73
    v_exp_f32 v74, v74
    s_waitcnt lgkmcnt(4)
    v_mfma_f32_32x32x16_bf16 v[96:111], v[16:19], v[64:67], v[96:111]
    v_exp_f32 v75, v75
    v_exp_f32 v76, v76
    v_exp_f32 v77, v77
    v_exp_f32 v78, v78
    v_exp_f32 v79, v79
    v_mfma_f32_32x32x16_bf16 v[192:207], v[128:131], v[144:147], v[192:207]
    v_cvt_pk_bf16_f32 v72, v72, v73
    v_cvt_pk_bf16_f32 v73, v74, v75
    v_cvt_pk_bf16_f32 v74, v76, v77
    v_cvt_pk_bf16_f32 v75, v78, v79
    v_exp_f32 v80, v80
    v_exp_f32 v81, v81
    s_waitcnt lgkmcnt(1)
    v_mfma_f32_32x32x16_bf16 v[96:111], v[20:23], v[72:75], v[96:111]
    v_exp_f32 v82, v82
    s_add_u32 m0, s38, 0
    s_add_u32 s17, s17, 8192
    buffer_load_dwordx4 v30, s[68:71], s17 offen lds
    v_exp_f32 v83, v83
    v_exp_f32 v84, v84
    v_exp_f32 v85, v85
    v_exp_f32 v86, v86
    v_exp_f32 v87, v87
    v_cvt_pk_bf16_f32 v80, v80, v81
    s_waitcnt lgkmcnt(0)
    v_mfma_f32_32x32x16_bf16 v[64:79], v[12:15], v[4:7], v[32:47]
    v_cvt_pk_bf16_f32 v81, v82, v83
    s_waitcnt vmcnt(4)
    ds_read_b64_tr_b16 v[136:137], v27 offset:0
    ds_read_b64_tr_b16 v[138:139], v27 offset:1024
    v_cvt_pk_bf16_f32 v82, v84, v85
    v_cvt_pk_bf16_f32 v83, v86, v87
    v_exp_f32 v88, v88
    v_exp_f32 v89, v89
    v_exp_f32 v90, v90
    v_mfma_f32_32x32x16_bf16 v[112:127], v[16:19], v[80:83], v[112:127]
    ds_read_b128 v[16:19], v25 offset:40256
    v_exp_f32 v91, v91
    v_exp_f32 v92, v92
    v_exp_f32 v93, v93
    v_exp_f32 v94, v94
    v_exp_f32 v95, v95
    v_mfma_f32_32x32x16_bf16 v[208:223], v[132:135], v[144:147], v[208:223]
    v_cvt_pk_bf16_f32 v88, v88, v89
    ds_read_b64_tr_b16 v[140:141], v27 offset:512
    ds_read_b64_tr_b16 v[142:143], v27 offset:1536
    v_cvt_pk_bf16_f32 v89, v90, v91
    buffer_load_dwordx4 v[156:159], v2, s[60:63], s18 offen offset:2048 sc1
    s_add_u32 s18, s18, 4096
    v_cvt_pk_bf16_f32 v90, v92, v93
    v_cvt_pk_bf16_f32 v91, v94, v95
    v_exp_f32 v64, v64
    v_exp_f32 v65, v65
    v_mfma_f32_32x32x16_bf16 v[112:127], v[20:23], v[88:91], v[112:127]
    ds_read_b128 v[20:23], v25 offset:40800
    v_exp_f32 v66, v66
    s_add_u32 m0, s38, 1024
    s_add_u32 s17, s17, 8192
    buffer_load_dwordx4 v30, s[68:71], s17 offen lds
    v_exp_f32 v67, v67
    v_exp_f32 v68, v68
    v_exp_f32 v69, v69
    v_exp_f32 v70, v70
    v_exp_f32 v71, v71
    v_cvt_pk_bf16_f32 v64, v64, v65
    v_mfma_f32_32x32x16_bf16 v[80:95], v[12:15], v[8:11], v[48:63]
    ds_read_b128 v[12:15], v24 offset:22528
    v_cvt_pk_bf16_f32 v65, v66, v67
    v_cvt_pk_bf16_f32 v66, v68, v69
    v_cvt_pk_bf16_f32 v67, v70, v71
    v_exp_f32 v72, v72
    v_exp_f32 v73, v73
    v_exp_f32 v74, v74
    s_waitcnt lgkmcnt(4)
    v_mfma_f32_32x32x16_bf16 v[96:111], v[16:19], v[64:67], v[96:111]
    v_exp_f32 v75, v75
    v_exp_f32 v76, v76
    v_exp_f32 v77, v77
    v_exp_f32 v78, v78
    v_exp_f32 v79, v79
    v_mfma_f32_32x32x16_bf16 v[192:207], v[136:139], v[148:151], v[192:207]
    v_cvt_pk_bf16_f32 v72, v72, v73
    v_cvt_pk_bf16_f32 v73, v74, v75
    v_cvt_pk_bf16_f32 v74, v76, v77
    v_cvt_pk_bf16_f32 v75, v78, v79
    v_exp_f32 v80, v80
    v_exp_f32 v81, v81
    s_waitcnt lgkmcnt(1)
    v_mfma_f32_32x32x16_bf16 v[96:111], v[20:23], v[72:75], v[96:111]
    v_exp_f32 v82, v82
    s_add_u32 m0, s21, 0
    s_add_u32 s17, s17, 8192
    buffer_load_dwordx4 v30, s[68:71], s17 offen lds
    v_exp_f32 v83, v83
    v_exp_f32 v84, v84
    v_exp_f32 v85, v85
    v_exp_f32 v86, v86
    v_exp_f32 v87, v87
    v_cvt_pk_bf16_f32 v80, v80, v81
    s_waitcnt lgkmcnt(0)
    v_mfma_f32_32x32x16_bf16 v[64:79], v[12:15], v[4:7], v[32:47]
    v_cvt_pk_bf16_f32 v81, v82, v83
    s_waitcnt vmcnt(4)
    ds_read_b64_tr_b16 v[128:129], v181 offset:0
    ds_read_b64_tr_b16 v[130:131], v181 offset:1024
    v_cvt_pk_bf16_f32 v82, v84, v85
    v_cvt_pk_bf16_f32 v83, v86, v87
    v_exp_f32 v88, v88
    v_exp_f32 v89, v89
    v_exp_f32 v90, v90
    v_mfma_f32_32x32x16_bf16 v[112:127], v[16:19], v[80:83], v[112:127]
    ds_read_b128 v[16:19], v25 offset:41344
    v_exp_f32 v91, v91
    v_exp_f32 v92, v92
    v_exp_f32 v93, v93
    v_exp_f32 v94, v94
    v_exp_f32 v95, v95
    v_mfma_f32_32x32x16_bf16 v[208:223], v[140:143], v[148:151], v[208:223]
    v_cvt_pk_bf16_f32 v88, v88, v89
    ds_read_b64_tr_b16 v[132:133], v181 offset:512
    ds_read_b64_tr_b16 v[134:135], v181 offset:1536
    v_cvt_pk_bf16_f32 v89, v90, v91
    buffer_load_dwordx4 v[144:147], v2, s[60:63], s18 offen offset:0 sc1
    v_cvt_pk_bf16_f32 v90, v92, v93
    v_cvt_pk_bf16_f32 v91, v94, v95
    v_exp_f32 v64, v64
    s_setprio 0
    v_exp_f32 v65, v65
    v_mfma_f32_32x32x16_bf16 v[112:127], v[20:23], v[88:91], v[112:127]
    ds_read_b128 v[20:23], v25 offset:41888
    v_exp_f32 v66, v66
    s_add_u32 m0, s21, 1024
    s_add_u32 s17, s17, 8192
    buffer_load_dwordx4 v30, s[68:71], s17 offen lds
    v_exp_f32 v67, v67
    v_exp_f32 v68, v68
    v_exp_f32 v69, v69
    v_exp_f32 v70, v70
    v_exp_f32 v71, v71
    v_cvt_pk_bf16_f32 v64, v64, v65
    v_mfma_f32_32x32x16_bf16 v[80:95], v[12:15], v[8:11], v[48:63]
    ds_read_b128 v[12:15], v24 offset:23552
    v_cvt_pk_bf16_f32 v65, v66, v67
    v_cvt_pk_bf16_f32 v66, v68, v69
    v_cvt_pk_bf16_f32 v67, v70, v71
    v_exp_f32 v72, v72
    v_exp_f32 v73, v73
    v_exp_f32 v74, v74
    s_waitcnt lgkmcnt(4)
    v_mfma_f32_32x32x16_bf16 v[96:111], v[16:19], v[64:67], v[96:111]
    v_exp_f32 v75, v75
    v_exp_f32 v76, v76
    v_exp_f32 v77, v77
    v_exp_f32 v78, v78
    v_exp_f32 v79, v79
    v_mfma_f32_32x32x16_bf16 v[192:207], v[128:131], v[152:155], v[192:207]
    v_cvt_pk_bf16_f32 v72, v72, v73
    v_cvt_pk_bf16_f32 v73, v74, v75
    v_cvt_pk_bf16_f32 v74, v76, v77
    v_cvt_pk_bf16_f32 v75, v78, v79
    v_exp_f32 v80, v80
    v_exp_f32 v81, v81
    s_waitcnt lgkmcnt(1)
    v_mfma_f32_32x32x16_bf16 v[96:111], v[20:23], v[72:75], v[96:111]
    v_exp_f32 v82, v82
    s_add_u32 m0, s16, 0
    s_add_u32 s17, s17, 8192
    buffer_load_dwordx4 v30, s[68:71], s17 offen lds
    v_exp_f32 v83, v83
    v_exp_f32 v84, v84
    v_exp_f32 v85, v85
    v_exp_f32 v86, v86
    v_exp_f32 v87, v87
    v_cvt_pk_bf16_f32 v80, v80, v81
    s_waitcnt lgkmcnt(0)
    v_mfma_f32_32x32x16_bf16 v[64:79], v[12:15], v[4:7], v[32:47]
    v_cvt_pk_bf16_f32 v81, v82, v83
    s_waitcnt vmcnt(4)
    ds_read_b64_tr_b16 v[136:137], v26 offset:0
    ds_read_b64_tr_b16 v[138:139], v26 offset:1024
    v_cvt_pk_bf16_f32 v82, v84, v85
    v_cvt_pk_bf16_f32 v83, v86, v87
    v_exp_f32 v88, v88
    v_exp_f32 v89, v89
    v_exp_f32 v90, v90
    v_mfma_f32_32x32x16_bf16 v[112:127], v[16:19], v[80:83], v[112:127]
    ds_read_b128 v[16:19], v25 offset:42432
    v_exp_f32 v91, v91
    v_exp_f32 v92, v92
    v_exp_f32 v93, v93
    v_exp_f32 v94, v94
    v_exp_f32 v95, v95
    v_mfma_f32_32x32x16_bf16 v[208:223], v[132:135], v[152:155], v[208:223]
    v_cvt_pk_bf16_f32 v88, v88, v89
    ds_read_b64_tr_b16 v[140:141], v26 offset:512
    ds_read_b64_tr_b16 v[142:143], v26 offset:1536
    v_cvt_pk_bf16_f32 v89, v90, v91
    buffer_load_dwordx4 v[148:151], v2, s[60:63], s18 offen offset:2048 sc1
    s_add_u32 s18, s18, 4096
    v_cvt_pk_bf16_f32 v90, v92, v93
    v_cvt_pk_bf16_f32 v91, v94, v95
    v_exp_f32 v64, v64
    v_exp_f32 v65, v65
    v_mfma_f32_32x32x16_bf16 v[112:127], v[20:23], v[88:91], v[112:127]
    ds_read_b128 v[20:23], v25 offset:42976
    v_exp_f32 v66, v66
    s_add_u32 m0, s16, 1024
    s_add_u32 s17, s17, 8192
    buffer_load_dwordx4 v30, s[68:71], s17 offen lds
    v_exp_f32 v67, v67
    v_exp_f32 v68, v68
    v_exp_f32 v69, v69
    v_exp_f32 v70, v70
    v_exp_f32 v71, v71
    s_waitcnt lgkmcnt(0)
    s_barrier
    v_cvt_pk_bf16_f32 v64, v64, v65
    v_mfma_f32_32x32x16_bf16 v[80:95], v[12:15], v[8:11], v[48:63]
    ds_read_b128 v[12:15], v24 offset:24576
    v_cvt_pk_bf16_f32 v65, v66, v67
    v_cvt_pk_bf16_f32 v66, v68, v69
    v_cvt_pk_bf16_f32 v67, v70, v71
    v_exp_f32 v72, v72
    v_exp_f32 v73, v73
    v_exp_f32 v74, v74
    v_mfma_f32_32x32x16_bf16 v[96:111], v[16:19], v[64:67], v[96:111]
    v_exp_f32 v75, v75
    v_exp_f32 v76, v76
    v_exp_f32 v77, v77
    v_exp_f32 v78, v78
    v_exp_f32 v79, v79
    v_mfma_f32_32x32x16_bf16 v[192:207], v[136:139], v[156:159], v[192:207]
    v_cvt_pk_bf16_f32 v72, v72, v73
    v_cvt_pk_bf16_f32 v73, v74, v75
    v_cvt_pk_bf16_f32 v74, v76, v77
    v_cvt_pk_bf16_f32 v75, v78, v79
    v_exp_f32 v80, v80
    v_exp_f32 v81, v81
    v_mfma_f32_32x32x16_bf16 v[96:111], v[20:23], v[72:75], v[96:111]
    v_exp_f32 v82, v82
    s_add_u32 m0, s38, 0
    s_add_u32 s17, s17, 8192
    buffer_load_dwordx4 v30, s[68:71], s17 offen lds
    v_exp_f32 v83, v83
    v_exp_f32 v84, v84
    v_exp_f32 v85, v85
    s_add_u32 m0, s7, 0
    s_nop 0
    buffer_load_dwordx4 v30, s[72:75], s8 offen lds
    v_exp_f32 v86, v86
    v_exp_f32 v87, v87
    v_cvt_pk_bf16_f32 v80, v80, v81
    s_waitcnt lgkmcnt(0)
    v_mfma_f32_32x32x16_bf16 v[64:79], v[12:15], v[4:7], v[32:47]
    v_cvt_pk_bf16_f32 v81, v82, v83
    s_waitcnt vmcnt(5)
    ds_read_b64_tr_b16 v[128:129], v27 offset:0
    ds_read_b64_tr_b16 v[130:131], v27 offset:1024
    v_cvt_pk_bf16_f32 v82, v84, v85
    v_cvt_pk_bf16_f32 v83, v86, v87
    v_exp_f32 v88, v88
    v_exp_f32 v89, v89
    v_exp_f32 v90, v90
    v_mfma_f32_32x32x16_bf16 v[112:127], v[16:19], v[80:83], v[112:127]
    ds_read_b128 v[16:19], v25 offset:52224
    v_exp_f32 v91, v91
    v_exp_f32 v92, v92
    v_exp_f32 v93, v93
    v_exp_f32 v94, v94
    v_exp_f32 v95, v95
    v_mfma_f32_32x32x16_bf16 v[208:223], v[140:143], v[156:159], v[208:223]
    v_cvt_pk_bf16_f32 v88, v88, v89
    ds_read_b64_tr_b16 v[132:133], v27 offset:512
    ds_read_b64_tr_b16 v[134:135], v27 offset:1536
    v_cvt_pk_bf16_f32 v89, v90, v91
    buffer_load_dwordx4 v[152:155], v2, s[60:63], s18 offen offset:0 sc1
    v_cvt_pk_bf16_f32 v90, v92, v93
    v_cvt_pk_bf16_f32 v91, v94, v95
    v_exp_f32 v64, v64
    s_setprio 3
    v_exp_f32 v65, v65
    v_mfma_f32_32x32x16_bf16 v[112:127], v[20:23], v[88:91], v[112:127]
    ds_read_b128 v[20:23], v25 offset:52768
    v_exp_f32 v66, v66
    s_add_u32 m0, s38, 1024
    s_add_u32 s17, s17, 8192
    buffer_load_dwordx4 v30, s[68:71], s17 offen lds
    v_exp_f32 v67, v67
    v_exp_f32 v68, v68
    v_exp_f32 v69, v69
    v_exp_f32 v70, v70
    v_exp_f32 v71, v71
    v_cvt_pk_bf16_f32 v64, v64, v65
    v_mfma_f32_32x32x16_bf16 v[80:95], v[12:15], v[8:11], v[48:63]
    ds_read_b128 v[12:15], v24 offset:25600
    v_cvt_pk_bf16_f32 v65, v66, v67
    s_add_u32 m0, s7, 1024
    s_add_u32 s8, s8, 8192
    buffer_load_dwordx4 v30, s[72:75], s8 offen lds
    v_cvt_pk_bf16_f32 v66, v68, v69
    v_cvt_pk_bf16_f32 v67, v70, v71
    v_exp_f32 v72, v72
    v_exp_f32 v73, v73
    v_exp_f32 v74, v74
    s_waitcnt lgkmcnt(4)
    v_mfma_f32_32x32x16_bf16 v[96:111], v[16:19], v[64:67], v[96:111]
    v_exp_f32 v75, v75
    v_exp_f32 v76, v76
    v_exp_f32 v77, v77
    v_exp_f32 v78, v78
    v_exp_f32 v79, v79
    v_mfma_f32_32x32x16_bf16 v[192:207], v[128:131], v[144:147], v[192:207]
    v_cvt_pk_bf16_f32 v72, v72, v73
    v_cvt_pk_bf16_f32 v73, v74, v75
    v_cvt_pk_bf16_f32 v74, v76, v77
    v_cvt_pk_bf16_f32 v75, v78, v79
    v_exp_f32 v80, v80
    v_exp_f32 v81, v81
    s_waitcnt lgkmcnt(1)
    v_mfma_f32_32x32x16_bf16 v[96:111], v[20:23], v[72:75], v[96:111]
    v_exp_f32 v82, v82
    s_add_u32 m0, s21, 0
    s_add_u32 s17, s17, 8192
    buffer_load_dwordx4 v30, s[68:71], s17 offen lds
    v_exp_f32 v83, v83
    v_exp_f32 v84, v84
    v_exp_f32 v85, v85
    s_add_u32 m0, s7, 2048
    s_add_u32 s8, s8, 8192
    buffer_load_dwordx4 v30, s[72:75], s8 offen lds
    v_exp_f32 v86, v86
    v_exp_f32 v87, v87
    v_cvt_pk_bf16_f32 v80, v80, v81
    s_waitcnt lgkmcnt(0)
    v_mfma_f32_32x32x16_bf16 v[64:79], v[12:15], v[4:7], v[32:47]
    v_cvt_pk_bf16_f32 v81, v82, v83
    s_waitcnt vmcnt(7)
    ds_read_b64_tr_b16 v[136:137], v181 offset:0
    ds_read_b64_tr_b16 v[138:139], v181 offset:1024
    v_cvt_pk_bf16_f32 v82, v84, v85
    v_cvt_pk_bf16_f32 v83, v86, v87
    v_exp_f32 v88, v88
    v_exp_f32 v89, v89
    v_exp_f32 v90, v90
    v_mfma_f32_32x32x16_bf16 v[112:127], v[16:19], v[80:83], v[112:127]
    ds_read_b128 v[16:19], v25 offset:53312
    v_exp_f32 v91, v91
    v_exp_f32 v92, v92
    v_exp_f32 v93, v93
    v_exp_f32 v94, v94
    v_exp_f32 v95, v95
    v_mfma_f32_32x32x16_bf16 v[208:223], v[132:135], v[144:147], v[208:223]
    v_cvt_pk_bf16_f32 v88, v88, v89
    ds_read_b64_tr_b16 v[140:141], v181 offset:512
    ds_read_b64_tr_b16 v[142:143], v181 offset:1536
    v_cvt_pk_bf16_f32 v89, v90, v91
    buffer_load_dwordx4 v[156:159], v2, s[60:63], s18 offen offset:2048 sc1
    s_add_u32 s18, s18, 4096
    v_cvt_pk_bf16_f32 v90, v92, v93
    v_cvt_pk_bf16_f32 v91, v94, v95
    v_exp_f32 v64, v64
    v_exp_f32 v65, v65
    v_mfma_f32_32x32x16_bf16 v[112:127], v[20:23], v[88:91], v[112:127]
    ds_read_b128 v[20:23], v25 offset:53856
    v_exp_f32 v66, v66
    s_add_u32 m0, s21, 1024
    s_add_u32 s17, s17, 8192
    buffer_load_dwordx4 v30, s[68:71], s17 offen lds
    v_exp_f32 v67, v67
    v_exp_f32 v68, v68
    v_exp_f32 v69, v69
    v_exp_f32 v70, v70
    v_exp_f32 v71, v71
    v_cvt_pk_bf16_f32 v64, v64, v65
    v_mfma_f32_32x32x16_bf16 v[80:95], v[12:15], v[8:11], v[48:63]
    ds_read_b128 v[12:15], v24 offset:26624
    v_cvt_pk_bf16_f32 v65, v66, v67
    s_add_u32 m0, s7, 3072
    s_add_u32 s8, s8, 8192
    buffer_load_dwordx4 v30, s[72:75], s8 offen lds
    v_cvt_pk_bf16_f32 v66, v68, v69
    v_cvt_pk_bf16_f32 v67, v70, v71
    v_exp_f32 v72, v72
    v_exp_f32 v73, v73
    v_exp_f32 v74, v74
    s_waitcnt lgkmcnt(4)
    v_mfma_f32_32x32x16_bf16 v[96:111], v[16:19], v[64:67], v[96:111]
    v_exp_f32 v75, v75
    v_exp_f32 v76, v76
    v_exp_f32 v77, v77
    v_exp_f32 v78, v78
    v_exp_f32 v79, v79
    v_mfma_f32_32x32x16_bf16 v[192:207], v[136:139], v[148:151], v[192:207]
    v_cvt_pk_bf16_f32 v72, v72, v73
    v_cvt_pk_bf16_f32 v73, v74, v75
    v_cvt_pk_bf16_f32 v74, v76, v77
    v_cvt_pk_bf16_f32 v75, v78, v79
    v_exp_f32 v80, v80
    v_exp_f32 v81, v81
    s_waitcnt lgkmcnt(1)
    v_mfma_f32_32x32x16_bf16 v[96:111], v[20:23], v[72:75], v[96:111]
    v_exp_f32 v82, v82
    s_add_u32 m0, s16, 0
    s_add_u32 s17, s17, 8192
    buffer_load_dwordx4 v30, s[68:71], s17 offen lds
    v_exp_f32 v83, v83
    v_exp_f32 v84, v84
    v_exp_f32 v85, v85
    s_add_u32 m0, s7, 4096
    s_add_u32 s8, s8, 8192
    buffer_load_dwordx4 v30, s[72:75], s8 offen lds
    v_exp_f32 v86, v86
    v_exp_f32 v87, v87
    v_cvt_pk_bf16_f32 v80, v80, v81
    s_waitcnt lgkmcnt(0)
    v_mfma_f32_32x32x16_bf16 v[64:79], v[12:15], v[4:7], v[32:47]
    v_cvt_pk_bf16_f32 v81, v82, v83
    s_waitcnt vmcnt(8)
    ds_read_b64_tr_b16 v[128:129], v26 offset:0
    ds_read_b64_tr_b16 v[130:131], v26 offset:1024
    v_cvt_pk_bf16_f32 v82, v84, v85
    v_cvt_pk_bf16_f32 v83, v86, v87
    v_exp_f32 v88, v88
    v_exp_f32 v89, v89
    v_exp_f32 v90, v90
    v_mfma_f32_32x32x16_bf16 v[112:127], v[16:19], v[80:83], v[112:127]
    ds_read_b128 v[16:19], v25 offset:54400
    v_exp_f32 v91, v91
    v_exp_f32 v92, v92
    v_exp_f32 v93, v93
    v_exp_f32 v94, v94
    v_exp_f32 v95, v95
    v_mfma_f32_32x32x16_bf16 v[208:223], v[140:143], v[148:151], v[208:223]
    v_cvt_pk_bf16_f32 v88, v88, v89
    ds_read_b64_tr_b16 v[132:133], v26 offset:512
    ds_read_b64_tr_b16 v[134:135], v26 offset:1536
    v_cvt_pk_bf16_f32 v89, v90, v91
    buffer_load_dwordx4 v[144:147], v2, s[60:63], s18 offen offset:0 sc1
    v_cvt_pk_bf16_f32 v90, v92, v93
    v_cvt_pk_bf16_f32 v91, v94, v95
    v_exp_f32 v64, v64
    s_setprio 2
    v_exp_f32 v65, v65
    v_mfma_f32_32x32x16_bf16 v[112:127], v[20:23], v[88:91], v[112:127]
    ds_read_b128 v[20:23], v25 offset:54944
    v_exp_f32 v66, v66
    s_add_u32 m0, s16, 1024
    s_add_u32 s17, s17, 8192
    buffer_load_dwordx4 v30, s[68:71], s17 offen lds
    v_exp_f32 v67, v67
    v_exp_f32 v68, v68
    v_exp_f32 v69, v69
    v_exp_f32 v70, v70
    v_exp_f32 v71, v71
    v_cvt_pk_bf16_f32 v64, v64, v65
    v_mfma_f32_32x32x16_bf16 v[80:95], v[12:15], v[8:11], v[48:63]
    ds_read_b128 v[12:15], v24 offset:27648
    v_cvt_pk_bf16_f32 v65, v66, v67
    s_add_u32 m0, s7, 5120
    s_add_u32 s8, s8, 8192
    buffer_load_dwordx4 v30, s[72:75], s8 offen lds
    v_cvt_pk_bf16_f32 v66, v68, v69
    v_cvt_pk_bf16_f32 v67, v70, v71
    v_exp_f32 v72, v72
    v_exp_f32 v73, v73
    v_exp_f32 v74, v74
    s_waitcnt lgkmcnt(4)
    v_mfma_f32_32x32x16_bf16 v[96:111], v[16:19], v[64:67], v[96:111]
    v_exp_f32 v75, v75
    v_exp_f32 v76, v76
    v_exp_f32 v77, v77
    v_exp_f32 v78, v78
    v_exp_f32 v79, v79
    v_mfma_f32_32x32x16_bf16 v[192:207], v[128:131], v[152:155], v[192:207]
    v_cvt_pk_bf16_f32 v72, v72, v73
    v_cvt_pk_bf16_f32 v73, v74, v75
    v_cvt_pk_bf16_f32 v74, v76, v77
    v_cvt_pk_bf16_f32 v75, v78, v79
    v_exp_f32 v80, v80
    v_exp_f32 v81, v81
    s_waitcnt lgkmcnt(1)
    v_mfma_f32_32x32x16_bf16 v[96:111], v[20:23], v[72:75], v[96:111]
    v_exp_f32 v82, v82
    s_add_u32 m0, s38, 0
    s_add_u32 s17, s17, 8192
    buffer_load_dwordx4 v30, s[68:71], s17 offen lds
    v_exp_f32 v83, v83
    v_exp_f32 v84, v84
    v_exp_f32 v85, v85
    s_add_u32 m0, s7, 6144
    s_add_u32 s8, s8, 8192
    buffer_load_dwordx4 v30, s[72:75], s8 offen lds
    v_exp_f32 v86, v86
    v_exp_f32 v87, v87
    v_cvt_pk_bf16_f32 v80, v80, v81
    s_waitcnt lgkmcnt(0)
    v_mfma_f32_32x32x16_bf16 v[64:79], v[12:15], v[4:7], v[32:47]
    v_cvt_pk_bf16_f32 v81, v82, v83
    s_waitcnt vmcnt(8)
    ds_read_b64_tr_b16 v[136:137], v27 offset:0
    ds_read_b64_tr_b16 v[138:139], v27 offset:1024
    v_cvt_pk_bf16_f32 v82, v84, v85
    v_cvt_pk_bf16_f32 v83, v86, v87
    v_exp_f32 v88, v88
    v_exp_f32 v89, v89
    v_exp_f32 v90, v90
    v_mfma_f32_32x32x16_bf16 v[112:127], v[16:19], v[80:83], v[112:127]
    ds_read_b128 v[16:19], v25 offset:55488
    v_exp_f32 v91, v91
    v_exp_f32 v92, v92
    v_exp_f32 v93, v93
    v_exp_f32 v94, v94
    v_exp_f32 v95, v95
    v_mfma_f32_32x32x16_bf16 v[208:223], v[132:135], v[152:155], v[208:223]
    v_cvt_pk_bf16_f32 v88, v88, v89
    ds_read_b64_tr_b16 v[140:141], v27 offset:512
    ds_read_b64_tr_b16 v[142:143], v27 offset:1536
    v_cvt_pk_bf16_f32 v89, v90, v91
    buffer_load_dwordx4 v[148:151], v2, s[60:63], s18 offen offset:2048 sc1
    s_add_u32 s18, s18, 4096
    v_cvt_pk_bf16_f32 v90, v92, v93
    v_cvt_pk_bf16_f32 v91, v94, v95
    v_exp_f32 v64, v64
    v_exp_f32 v65, v65
    v_mfma_f32_32x32x16_bf16 v[112:127], v[20:23], v[88:91], v[112:127]
    ds_read_b128 v[20:23], v25 offset:56032
    v_exp_f32 v66, v66
    s_add_u32 m0, s38, 1024
    s_add_u32 s17, s17, 8192
    buffer_load_dwordx4 v30, s[68:71], s17 offen lds
    v_exp_f32 v67, v67
    v_exp_f32 v68, v68
    v_exp_f32 v69, v69
    v_exp_f32 v70, v70
    v_exp_f32 v71, v71
    v_cvt_pk_bf16_f32 v64, v64, v65
    v_mfma_f32_32x32x16_bf16 v[80:95], v[12:15], v[8:11], v[48:63]
    ds_read_b128 v[12:15], v24 offset:28672
    v_cvt_pk_bf16_f32 v65, v66, v67
    s_add_u32 m0, s7, 7168
    s_add_u32 s8, s8, 8192
    buffer_load_dwordx4 v30, s[72:75], s8 offen lds
    v_cvt_pk_bf16_f32 v66, v68, v69
    v_cvt_pk_bf16_f32 v67, v70, v71
    v_exp_f32 v72, v72
    v_exp_f32 v73, v73
    v_exp_f32 v74, v74
    s_waitcnt lgkmcnt(4)
    v_mfma_f32_32x32x16_bf16 v[96:111], v[16:19], v[64:67], v[96:111]
    v_exp_f32 v75, v75
    v_exp_f32 v76, v76
    v_exp_f32 v77, v77
    v_exp_f32 v78, v78
    v_exp_f32 v79, v79
    v_mfma_f32_32x32x16_bf16 v[192:207], v[136:139], v[156:159], v[192:207]
    v_cvt_pk_bf16_f32 v72, v72, v73
    v_cvt_pk_bf16_f32 v73, v74, v75
    v_cvt_pk_bf16_f32 v74, v76, v77
    v_cvt_pk_bf16_f32 v75, v78, v79
    v_exp_f32 v80, v80
    v_exp_f32 v81, v81
    s_waitcnt lgkmcnt(1)
    v_mfma_f32_32x32x16_bf16 v[96:111], v[20:23], v[72:75], v[96:111]
    v_exp_f32 v82, v82
    v_exp_f32 v83, v83
    v_exp_f32 v84, v84
    v_exp_f32 v85, v85
    v_exp_f32 v86, v86
    v_exp_f32 v87, v87
    v_cvt_pk_bf16_f32 v80, v80, v81
    s_waitcnt lgkmcnt(0)
    v_mfma_f32_32x32x16_bf16 v[64:79], v[12:15], v[4:7], v[32:47]
    v_cvt_pk_bf16_f32 v81, v82, v83
    s_waitcnt vmcnt(6)
    ds_read_b64_tr_b16 v[128:129], v181 offset:0
    ds_read_b64_tr_b16 v[130:131], v181 offset:1024
    v_cvt_pk_bf16_f32 v82, v84, v85
    v_cvt_pk_bf16_f32 v83, v86, v87
    v_exp_f32 v88, v88
    v_exp_f32 v89, v89
    v_exp_f32 v90, v90
    v_mfma_f32_32x32x16_bf16 v[112:127], v[16:19], v[80:83], v[112:127]
    ds_read_b128 v[16:19], v25 offset:56576
    v_exp_f32 v91, v91
    v_exp_f32 v92, v92
    v_exp_f32 v93, v93
    v_exp_f32 v94, v94
    v_exp_f32 v95, v95
    v_mfma_f32_32x32x16_bf16 v[208:223], v[140:143], v[156:159], v[208:223]
    v_cvt_pk_bf16_f32 v88, v88, v89
    ds_read_b64_tr_b16 v[132:133], v181 offset:512
    ds_read_b64_tr_b16 v[134:135], v181 offset:1536
    v_cvt_pk_bf16_f32 v89, v90, v91
    v_cvt_pk_bf16_f32 v90, v92, v93
    v_cvt_pk_bf16_f32 v91, v94, v95
    v_exp_f32 v64, v64
    s_setprio 1
    v_exp_f32 v65, v65
    v_mfma_f32_32x32x16_bf16 v[112:127], v[20:23], v[88:91], v[112:127]
    ds_read_b128 v[20:23], v25 offset:57120
    v_exp_f32 v66, v66
    v_exp_f32 v67, v67
    v_exp_f32 v68, v68
    v_exp_f32 v69, v69
    v_exp_f32 v70, v70
    v_exp_f32 v71, v71
    v_cvt_pk_bf16_f32 v64, v64, v65
    v_mfma_f32_32x32x16_bf16 v[80:95], v[12:15], v[8:11], v[48:63]
    ds_read_b128 v[12:15], v24 offset:29696
    v_cvt_pk_bf16_f32 v65, v66, v67
    v_cvt_pk_bf16_f32 v66, v68, v69
    v_cvt_pk_bf16_f32 v67, v70, v71
    v_exp_f32 v72, v72
    v_exp_f32 v73, v73
    v_exp_f32 v74, v74
    s_waitcnt lgkmcnt(4)
    v_mfma_f32_32x32x16_bf16 v[96:111], v[16:19], v[64:67], v[96:111]
    v_exp_f32 v75, v75
    v_exp_f32 v76, v76
    v_exp_f32 v77, v77
    v_exp_f32 v78, v78
    v_exp_f32 v79, v79
    v_mfma_f32_32x32x16_bf16 v[192:207], v[128:131], v[144:147], v[192:207]
    v_cvt_pk_bf16_f32 v72, v72, v73
    v_cvt_pk_bf16_f32 v73, v74, v75
    v_cvt_pk_bf16_f32 v74, v76, v77
    v_cvt_pk_bf16_f32 v75, v78, v79
    v_exp_f32 v80, v80
    v_exp_f32 v81, v81
    s_waitcnt lgkmcnt(1)
    v_mfma_f32_32x32x16_bf16 v[96:111], v[20:23], v[72:75], v[96:111]
    v_exp_f32 v82, v82
    v_exp_f32 v83, v83
    v_exp_f32 v84, v84
    v_exp_f32 v85, v85
    v_exp_f32 v86, v86
    v_exp_f32 v87, v87
    v_cvt_pk_bf16_f32 v80, v80, v81
    s_waitcnt lgkmcnt(0)
    v_mfma_f32_32x32x16_bf16 v[64:79], v[12:15], v[4:7], v[32:47]
    v_cvt_pk_bf16_f32 v81, v82, v83
    s_waitcnt vmcnt(1)
    ds_read_b64_tr_b16 v[136:137], v26 offset:0
    ds_read_b64_tr_b16 v[138:139], v26 offset:1024
    v_cvt_pk_bf16_f32 v82, v84, v85
    v_cvt_pk_bf16_f32 v83, v86, v87
    v_exp_f32 v88, v88
    v_exp_f32 v89, v89
    v_exp_f32 v90, v90
    v_mfma_f32_32x32x16_bf16 v[112:127], v[16:19], v[80:83], v[112:127]
    ds_read_b128 v[16:19], v25 offset:57664
    v_exp_f32 v91, v91
    v_exp_f32 v92, v92
    v_exp_f32 v93, v93
    v_exp_f32 v94, v94
    v_exp_f32 v95, v95
    v_mfma_f32_32x32x16_bf16 v[208:223], v[132:135], v[144:147], v[208:223]
    v_cvt_pk_bf16_f32 v88, v88, v89
    ds_read_b64_tr_b16 v[140:141], v26 offset:512
    ds_read_b64_tr_b16 v[142:143], v26 offset:1536
    v_cvt_pk_bf16_f32 v89, v90, v91
    v_cvt_pk_bf16_f32 v90, v92, v93
    v_cvt_pk_bf16_f32 v91, v94, v95
    v_exp_f32 v64, v64
    v_exp_f32 v65, v65
    v_mfma_f32_32x32x16_bf16 v[112:127], v[20:23], v[88:91], v[112:127]
    ds_read_b128 v[20:23], v25 offset:58208
    v_exp_f32 v66, v66
    v_exp_f32 v67, v67
    v_exp_f32 v68, v68
    v_exp_f32 v69, v69
    v_exp_f32 v70, v70
    v_exp_f32 v71, v71
    v_cvt_pk_bf16_f32 v64, v64, v65
    v_mfma_f32_32x32x16_bf16 v[80:95], v[12:15], v[8:11], v[48:63]
    ds_read_b128 v[12:15], v24 offset:30720
    v_cvt_pk_bf16_f32 v65, v66, v67
    v_cvt_pk_bf16_f32 v66, v68, v69
    v_cvt_pk_bf16_f32 v67, v70, v71
    v_exp_f32 v72, v72
    v_exp_f32 v73, v73
    v_exp_f32 v74, v74
    s_waitcnt lgkmcnt(4)
    v_mfma_f32_32x32x16_bf16 v[96:111], v[16:19], v[64:67], v[96:111]
    v_exp_f32 v75, v75
    v_exp_f32 v76, v76
    v_exp_f32 v77, v77
    v_exp_f32 v78, v78
    v_exp_f32 v79, v79
    v_mfma_f32_32x32x16_bf16 v[192:207], v[136:139], v[148:151], v[192:207]
    v_cvt_pk_bf16_f32 v72, v72, v73
    v_cvt_pk_bf16_f32 v73, v74, v75
    v_cvt_pk_bf16_f32 v74, v76, v77
    v_cvt_pk_bf16_f32 v75, v78, v79
    v_exp_f32 v80, v80
    v_exp_f32 v81, v81
    s_waitcnt lgkmcnt(1)
    v_mfma_f32_32x32x16_bf16 v[96:111], v[20:23], v[72:75], v[96:111]
    v_exp_f32 v82, v82
    v_exp_f32 v83, v83
    v_exp_f32 v84, v84
    v_exp_f32 v85, v85
    v_exp_f32 v86, v86
    v_exp_f32 v87, v87
    v_cvt_pk_bf16_f32 v80, v80, v81
    s_waitcnt lgkmcnt(0)
    v_mfma_f32_32x32x16_bf16 v[64:79], v[12:15], v[4:7], v[32:47]
    v_cvt_pk_bf16_f32 v81, v82, v83
    v_cvt_pk_bf16_f32 v82, v84, v85
    v_cvt_pk_bf16_f32 v83, v86, v87
    v_exp_f32 v88, v88
    v_exp_f32 v89, v89
    v_exp_f32 v90, v90
    v_mfma_f32_32x32x16_bf16 v[112:127], v[16:19], v[80:83], v[112:127]
    ds_read_b128 v[16:19], v25 offset:58752
    v_exp_f32 v91, v91
    v_exp_f32 v92, v92
    v_exp_f32 v93, v93
    v_exp_f32 v94, v94
    v_exp_f32 v95, v95
    v_mfma_f32_32x32x16_bf16 v[208:223], v[140:143], v[148:151], v[208:223]
    v_cvt_pk_bf16_f32 v88, v88, v89
    v_cvt_pk_bf16_f32 v89, v90, v91
    v_cvt_pk_bf16_f32 v90, v92, v93
    v_cvt_pk_bf16_f32 v91, v94, v95
    v_exp_f32 v64, v64
    s_setprio 0
    v_exp_f32 v65, v65
    v_mfma_f32_32x32x16_bf16 v[112:127], v[20:23], v[88:91], v[112:127]
    ds_read_b128 v[20:23], v25 offset:59296
    v_exp_f32 v66, v66
    v_exp_f32 v67, v67
    v_exp_f32 v68, v68
    v_exp_f32 v69, v69
    v_exp_f32 v70, v70
    v_exp_f32 v71, v71
    v_cvt_pk_bf16_f32 v64, v64, v65
    v_mfma_f32_32x32x16_bf16 v[80:95], v[12:15], v[8:11], v[48:63]
    ds_read_b128 v[12:15], v24 offset:31744
    v_cvt_pk_bf16_f32 v65, v66, v67
    v_cvt_pk_bf16_f32 v66, v68, v69
    v_cvt_pk_bf16_f32 v67, v70, v71
    v_exp_f32 v72, v72
    v_exp_f32 v73, v73
    v_exp_f32 v74, v74
    s_waitcnt lgkmcnt(2)
    v_mfma_f32_32x32x16_bf16 v[96:111], v[16:19], v[64:67], v[96:111]
    v_exp_f32 v75, v75
    v_exp_f32 v76, v76
    v_exp_f32 v77, v77
    v_exp_f32 v78, v78
    v_exp_f32 v79, v79
    v_cvt_pk_bf16_f32 v72, v72, v73
    v_cvt_pk_bf16_f32 v73, v74, v75
    v_cvt_pk_bf16_f32 v74, v76, v77
    v_cvt_pk_bf16_f32 v75, v78, v79
    v_exp_f32 v80, v80
    v_exp_f32 v81, v81
    s_waitcnt lgkmcnt(1)
    v_mfma_f32_32x32x16_bf16 v[96:111], v[20:23], v[72:75], v[96:111]
    v_exp_f32 v82, v82
    v_exp_f32 v83, v83
    v_exp_f32 v84, v84
    v_exp_f32 v85, v85
    v_exp_f32 v86, v86
    v_exp_f32 v87, v87
    v_cvt_pk_bf16_f32 v80, v80, v81
    s_waitcnt lgkmcnt(0)
    v_mfma_f32_32x32x16_bf16 v[64:79], v[12:15], v[4:7], v[32:47]
    v_cvt_pk_bf16_f32 v81, v82, v83
    v_cvt_pk_bf16_f32 v82, v84, v85
    v_cvt_pk_bf16_f32 v83, v86, v87
    v_exp_f32 v88, v88
    v_exp_f32 v89, v89
    v_exp_f32 v90, v90
    v_mfma_f32_32x32x16_bf16 v[112:127], v[16:19], v[80:83], v[112:127]
    ds_read_b128 v[16:19], v25 offset:59840
    v_exp_f32 v91, v91
    v_exp_f32 v92, v92
    v_exp_f32 v93, v93
    v_exp_f32 v94, v94
    v_exp_f32 v95, v95
    v_cvt_pk_bf16_f32 v88, v88, v89
    v_cvt_pk_bf16_f32 v89, v90, v91
    v_cvt_pk_bf16_f32 v90, v92, v93
    v_cvt_pk_bf16_f32 v91, v94, v95
    v_exp_f32 v64, v64
    v_exp_f32 v65, v65
    v_mfma_f32_32x32x16_bf16 v[112:127], v[20:23], v[88:91], v[112:127]
    ds_read_b128 v[20:23], v25 offset:60384
    v_exp_f32 v66, v66
    v_exp_f32 v67, v67
    v_exp_f32 v68, v68
    v_exp_f32 v69, v69
    v_exp_f32 v70, v70
    v_exp_f32 v71, v71
    v_cvt_pk_bf16_f32 v64, v64, v65
    v_mfma_f32_32x32x16_bf16 v[80:95], v[12:15], v[8:11], v[48:63]
    v_cvt_pk_bf16_f32 v65, v66, v67
    v_cvt_pk_bf16_f32 v66, v68, v69
    v_cvt_pk_bf16_f32 v67, v70, v71
    v_exp_f32 v72, v72
    v_exp_f32 v73, v73
    v_exp_f32 v74, v74
    s_waitcnt lgkmcnt(1)
    v_mfma_f32_32x32x16_bf16 v[96:111], v[16:19], v[64:67], v[96:111]
    v_exp_f32 v75, v75
    v_exp_f32 v76, v76
    v_exp_f32 v77, v77
    v_exp_f32 v78, v78
    v_exp_f32 v79, v79
    v_cvt_pk_bf16_f32 v72, v72, v73
    v_cvt_pk_bf16_f32 v73, v74, v75
    v_cvt_pk_bf16_f32 v74, v76, v77
    v_cvt_pk_bf16_f32 v75, v78, v79
    v_exp_f32 v80, v80
    v_exp_f32 v81, v81
    s_waitcnt lgkmcnt(0)
    v_mfma_f32_32x32x16_bf16 v[96:111], v[20:23], v[72:75], v[96:111]
    v_exp_f32 v82, v82
    v_exp_f32 v83, v83
    v_exp_f32 v84, v84
    v_exp_f32 v85, v85
    v_exp_f32 v86, v86
    v_exp_f32 v87, v87
    v_cvt_pk_bf16_f32 v80, v80, v81
    v_cvt_pk_bf16_f32 v81, v82, v83
    v_cvt_pk_bf16_f32 v82, v84, v85
    v_cvt_pk_bf16_f32 v83, v86, v87
    v_exp_f32 v88, v88
    v_exp_f32 v89, v89
    v_exp_f32 v90, v90
    v_mfma_f32_32x32x16_bf16 v[112:127], v[16:19], v[80:83], v[112:127]
    v_exp_f32 v91, v91
    v_exp_f32 v92, v92
    v_exp_f32 v93, v93
    v_exp_f32 v94, v94
    v_exp_f32 v95, v95
    v_cvt_pk_bf16_f32 v88, v88, v89
    v_cvt_pk_bf16_f32 v89, v90, v91
    v_cvt_pk_bf16_f32 v90, v92, v93
    v_cvt_pk_bf16_f32 v91, v94, v95
    s_nop 1
    v_mfma_f32_32x32x16_bf16 v[112:127], v[20:23], v[88:91], v[112:127]
    s_setprio 0
    v_add_u32 v24, s16, v2
    s_xor_b32 s9, s3, 4
    s_lshl_b32 s10, s9, 11
    s_add_u32 s10, s10, 143360
    v_add_u32 v25, s10, v2
    s_lshl_b32 s9, s9, 8
    s_add_u32 s9, s9, 135168
    v_lshl_add_u32 v29, v1, 2, s9
    s_lshl_b32 s9, s3, 8
    s_add_u32 s9, s9, 135168
    v_lshl_add_u32 v28, v1, 2, s9
    s_waitcnt vmcnt(0)
    s_cmp_lg_u32 s96, 0
    s_cbranch_scc1 L_k1_17
    ds_write_b128 v24, v[112:115] offset:0
    ds_write_b128 v24, v[116:119] offset:1024
    ds_write_b32 v28, v120
    s_branch L_kj_18
L_k1_17:
    ds_write_b128 v24, v[96:99] offset:0
    ds_write_b128 v24, v[100:103] offset:1024
    ds_write_b32 v28, v104
    v_mov_b32 v96, v112
    v_mov_b32 v97, v113
    v_mov_b32 v98, v114
    v_mov_b32 v99, v115
    v_mov_b32 v100, v116
    v_mov_b32 v101, v117
    v_mov_b32 v102, v118
    v_mov_b32 v103, v119
    v_mov_b32 v104, v120
L_kj_18:
    s_nop 1
    s_waitcnt lgkmcnt(0)
    s_barrier
    ds_read_b128 v[112:115], v25 offset:0
    ds_read_b128 v[116:119], v25 offset:1024
    ds_read_b32 v120, v29
    s_mov_b32 s9, 8192
    s_cmp_eq_u32 s97, 1
    s_cselect_b32 s9, 40960, s9
    s_cmp_eq_u32 s97, 2
    s_cselect_b32 s9, 82944, s9
    s_cmp_eq_u32 s97, 3
    s_cselect_b32 s9, 99328, s9
    v_lshl_add_u32 v26, v189, 8, v188
    v_add_u32 v26, s9, v26
    s_waitcnt lgkmcnt(2)
    v_add_f32 v96, v96, v112
    v_add_f32 v97, v97, v113
    v_add_f32 v98, v98, v114
    v_add_f32 v99, v99, v115
    s_waitcnt lgkmcnt(1)
    v_add_f32 v100, v100, v116
    v_add_f32 v101, v101, v117
    v_add_f32 v102, v102, v118
    v_add_f32 v103, v103, v119
    s_waitcnt lgkmcnt(0)
    v_add_f32 v104, v104, v120
    v_rcp_f32 v104, v104
    s_nop 0
    v_pk_mul_f32 v[96:97], v[96:97], v[104:105] op_sel_hi:[1,0]
    v_pk_mul_f32 v[98:99], v[98:99], v[104:105] op_sel_hi:[1,0]
    v_pk_mul_f32 v[100:101], v[100:101], v[104:105] op_sel_hi:[1,0]
    v_pk_mul_f32 v[102:103], v[102:103], v[104:105] op_sel_hi:[1,0]
    v_cvt_pk_bf16_f32 v112, v96, v97
    v_cvt_pk_bf16_f32 v113, v98, v99
    v_cvt_pk_bf16_f32 v114, v100, v101
    v_cvt_pk_bf16_f32 v115, v102, v103
    buffer_store_dwordx4 v[112:115], v2, s[64:67], s43 offen sc1
    ds_read_b64_tr_b16 v[32:33], v26 offset:0
    ds_read_b64_tr_b16 v[34:35], v26 offset:1024
    ds_read_b64_tr_b16 v[36:37], v26 offset:512
    ds_read_b64_tr_b16 v[38:39], v26 offset:1536
    ds_read_b64_tr_b16 v[40:41], v26 offset:2048
    ds_read_b64_tr_b16 v[42:43], v26 offset:3072
    ds_read_b64_tr_b16 v[44:45], v26 offset:2560
    ds_read_b64_tr_b16 v[46:47], v26 offset:3584
    ds_read_b64_tr_b16 v[48:49], v26 offset:4096
    ds_read_b64_tr_b16 v[50:51], v26 offset:5120
    ds_read_b64_tr_b16 v[52:53], v26 offset:4608
    ds_read_b64_tr_b16 v[54:55], v26 offset:5632
    ds_read_b64_tr_b16 v[56:57], v26 offset:6144
    ds_read_b64_tr_b16 v[58:59], v26 offset:7168
    ds_read_b64_tr_b16 v[60:61], v26 offset:6656
    ds_read_b64_tr_b16 v[62:63], v26 offset:7680
    ds_read_b64_tr_b16 v[64:65], v26 offset:8192
    ds_read_b64_tr_b16 v[66:67], v26 offset:9216
    ds_read_b64_tr_b16 v[68:69], v26 offset:8704
    ds_read_b64_tr_b16 v[70:71], v26 offset:9728
    ds_read_b64_tr_b16 v[72:73], v26 offset:10240
    ds_read_b64_tr_b16 v[74:75], v26 offset:11264
    ds_read_b64_tr_b16 v[76:77], v26 offset:10752
    ds_read_b64_tr_b16 v[78:79], v26 offset:11776
    ds_read_b64_tr_b16 v[80:81], v26 offset:12288
    ds_read_b64_tr_b16 v[82:83], v26 offset:13312
    ds_read_b64_tr_b16 v[84:85], v26 offset:12800
    ds_read_b64_tr_b16 v[86:87], v26 offset:13824
    ds_read_b64_tr_b16 v[88:89], v26 offset:14336
    ds_read_b64_tr_b16 v[90:91], v26 offset:15360
    ds_read_b64_tr_b16 v[92:93], v26 offset:14848
    ds_read_b64_tr_b16 v[94:95], v26 offset:15872
    v_lshlrev_b32 v240, 16, v160
    v_and_b32 v241, 0xffff0000, v160
    v_lshlrev_b32 v248, 16, v164
    v_and_b32 v249, 0xffff0000, v164
    v_lshlrev_b32 v242, 16, v161
    v_and_b32 v243, 0xffff0000, v161
    v_lshlrev_b32 v250, 16, v165
    v_and_b32 v251, 0xffff0000, v165
    v_lshlrev_b32 v244, 16, v162
    v_and_b32 v245, 0xffff0000, v162
    v_lshlrev_b32 v252, 16, v166
    v_and_b32 v253, 0xffff0000, v166
    v_lshlrev_b32 v246, 16, v163
    v_and_b32 v247, 0xffff0000, v163
    v_lshlrev_b32 v254, 16, v167
    v_and_b32 v255, 0xffff0000, v167
    v_pk_add_f32 v[240:241], v[240:241], v[248:249]
    v_pk_add_f32 v[242:243], v[242:243], v[250:251]
    v_pk_add_f32 v[244:245], v[244:245], v[252:253]
    v_pk_add_f32 v[246:247], v[246:247], v[254:255]
    s_add_u32 s9, s3, 2
    s_and_b32 s9, s9, 7
    s_lshl_b32 s10, s9, 11
    s_add_u32 s10, s10, 24576
    v_add_u32 v13, s10, v2
    s_lshl_b32 s10, s3, 11
    s_add_u32 s10, s10, 24576
    v_add_u32 v17, s10, v2
    s_add_u32 s9, s3, 4
    s_and_b32 s9, s9, 7
    s_lshl_b32 s10, s9, 11
    s_add_u32 s10, s10, 117760
    v_add_u32 v14, s10, v2
    s_lshl_b32 s10, s3, 11
    s_add_u32 s10, s10, 117760
    v_add_u32 v18, s10, v2
    s_add_u32 s9, s3, 6
    s_and_b32 s9, s9, 7
    s_lshl_b32 s10, s9, 11
    s_cmp_ge_u32 s9, 4
    s_cselect_b32 s11, 49152, 0
    s_add_u32 s10, s10, s11
    v_add_u32 v15, s10, v2
    s_lshl_b32 s10, s3, 11
    s_cmp_ge_u32 s3, 4
    s_cselect_b32 s11, 49152, 0
    s_add_u32 s10, s10, s11
    v_add_u32 v19, s10, v2
    s_lshl_b32 s26, s97, 14
    s_lshl_b32 s10, s95, 10
    s_add_u32 s26, s26, s10
    v_add_u32 v4, 4096, v2
    v_add_u32 v5, 8192, v2
    v_add_u32 v6, 12288, v2
    s_mov_b32 s42, 0x4000
L_orep_19:
    buffer_load_dwordx4 v[96:99], v2, s[64:67], s26 offen offset:0 sc1
    buffer_load_dwordx4 v[100:103], v2, s[64:67], s26 offen offset:2048 sc1
    buffer_load_dwordx4 v[104:107], v4, s[64:67], s26 offen offset:0 sc1
    buffer_load_dwordx4 v[108:111], v4, s[64:67], s26 offen offset:2048 sc1
    buffer_load_dwordx4 v[112:115], v5, s[64:67], s26 offen offset:0 sc1
    buffer_load_dwordx4 v[116:119], v5, s[64:67], s26 offen offset:2048 sc1
    buffer_load_dwordx4 v[120:123], v6, s[64:67], s26 offen offset:0 sc1
    buffer_load_dwordx4 v[124:127], v6, s[64:67], s26 offen offset:2048 sc1
    s_waitcnt vmcnt(7) lgkmcnt(15)
    v_mfma_f32_32x32x16_bf16 v[128:143], v[32:35], v[96:99], v[192:207]
    v_mfma_f32_32x32x16_bf16 v[144:159], v[36:39], v[96:99], v[208:223]
    v_max3_u32 v8, v96, v97, v98
    v_mov_b32 v9, v99
    s_waitcnt vmcnt(6)
    v_mfma_f32_32x32x16_bf16 v[128:143], v[40:43], v[100:103], v[128:143]
    v_mfma_f32_32x32x16_bf16 v[144:159], v[44:47], v[100:103], v[144:159]
    v_max3_u32 v8, v8, v100, v101
    v_max3_u32 v9, v9, v102, v103
    s_waitcnt vmcnt(5)
    v_mfma_f32_32x32x16_bf16 v[128:143], v[48:51], v[104:107], v[128:143]
    v_mfma_f32_32x32x16_bf16 v[144:159], v[52:55], v[104:107], v[144:159]
    v_max3_u32 v8, v8, v104, v105
    v_max3_u32 v9, v9, v106, v107
    s_waitcnt vmcnt(4)
    v_mfma_f32_32x32x16_bf16 v[128:143], v[56:59], v[108:111], v[128:143]
    v_mfma_f32_32x32x16_bf16 v[144:159], v[60:63], v[108:111], v[144:159]
    v_max3_u32 v8, v8, v108, v109
    v_max3_u32 v9, v9, v110, v111
    s_waitcnt vmcnt(3) lgkmcnt(14)
    v_mfma_f32_32x32x16_bf16 v[128:143], v[64:67], v[112:115], v[128:143]
    s_waitcnt lgkmcnt(12)
    v_mfma_f32_32x32x16_bf16 v[144:159], v[68:71], v[112:115], v[144:159]
    v_max3_u32 v8, v8, v112, v113
    v_max3_u32 v9, v9, v114, v115
    s_waitcnt vmcnt(2) lgkmcnt(10)
    v_mfma_f32_32x32x16_bf16 v[128:143], v[72:75], v[116:119], v[128:143]
    s_waitcnt lgkmcnt(8)
    v_mfma_f32_32x32x16_bf16 v[144:159], v[76:79], v[116:119], v[144:159]
    v_max3_u32 v8, v8, v116, v117
    v_max3_u32 v9, v9, v118, v119
    s_waitcnt vmcnt(1) lgkmcnt(6)
    v_mfma_f32_32x32x16_bf16 v[128:143], v[80:83], v[120:123], v[128:143]
    s_waitcnt lgkmcnt(4)
    v_mfma_f32_32x32x16_bf16 v[144:159], v[84:87], v[120:123], v[144:159]
    v_max3_u32 v8, v8, v120, v121
    v_max3_u32 v9, v9, v122, v123
    s_waitcnt vmcnt(0) lgkmcnt(2)
    v_mfma_f32_32x32x16_bf16 v[128:143], v[88:91], v[124:127], v[128:143]
    s_waitcnt lgkmcnt(0)
    v_mfma_f32_32x32x16_bf16 v[144:159], v[92:95], v[124:127], v[144:159]
    v_max3_u32 v8, v8, v124, v125
    v_max3_u32 v9, v9, v126, v127
    v_max_u32 v8, v8, v9
    v_cmp_eq_u32 vcc, -1, v8
    s_nop 4
    s_cbranch_vccz L_ook_20
    s_nop 15
    s_sub_u32 s42, s42, 1
    s_cmp_lg_u32 s42, 0
    s_cbranch_scc1 L_orep_19
L_ook_20:
    s_cmp_eq_u32 s97, 1
    s_cbranch_scc1 L_rs1_23
    s_cmp_eq_u32 s97, 2
    s_cbranch_scc1 L_rs2_24
    s_cmp_eq_u32 s97, 3
    s_cbranch_scc1 L_rs3_25
L_rs0_22:
    ds_write_b128 v13, v[136:139] offset:0
    ds_write_b128 v13, v[140:143] offset:1024
    ds_write_b128 v14, v[144:147] offset:0
    ds_write_b128 v14, v[148:151] offset:1024
    ds_write_b128 v15, v[152:155] offset:0
    ds_write_b128 v15, v[156:159] offset:1024
    v_pk_mov_b32 v[160:161], v[128:129], v[128:129] op_sel:[0,1]
    v_pk_mov_b32 v[162:163], v[130:131], v[130:131] op_sel:[0,1]
    v_pk_mov_b32 v[164:165], v[132:133], v[132:133] op_sel:[0,1]
    v_pk_mov_b32 v[166:167], v[134:135], v[134:135] op_sel:[0,1]
    s_branch L_rsj_21
L_rs1_23:
    ds_write_b128 v13, v[144:147] offset:0
    ds_write_b128 v13, v[148:151] offset:1024
    ds_write_b128 v14, v[152:155] offset:0
    ds_write_b128 v14, v[156:159] offset:1024
    ds_write_b128 v15, v[128:131] offset:0
    ds_write_b128 v15, v[132:135] offset:1024
    v_pk_mov_b32 v[160:161], v[136:137], v[136:137] op_sel:[0,1]
    v_pk_mov_b32 v[162:163], v[138:139], v[138:139] op_sel:[0,1]
    v_pk_mov_b32 v[164:165], v[140:141], v[140:141] op_sel:[0,1]
    v_pk_mov_b32 v[166:167], v[142:143], v[142:143] op_sel:[0,1]
    s_branch L_rsj_21
L_rs2_24:
    ds_write_b128 v13, v[152:155] offset:0
    ds_write_b128 v13, v[156:159] offset:1024
    ds_write_b128 v14, v[128:131] offset:0
    ds_write_b128 v14, v[132:135] offset:1024
    ds_write_b128 v15, v[136:139] offset:0
    ds_write_b128 v15, v[140:143] offset:1024
    v_pk_mov_b32 v[160:161], v[144:145], v[144:145] op_sel:[0,1]
    v_pk_mov_b32 v[162:163], v[146:147], v[146:147] op_sel:[0,1]
    v_pk_mov_b32 v[164:165], v[148:149], v[148:149] op_sel:[0,1]
    v_pk_mov_b32 v[166:167], v[150:151], v[150:151] op_sel:[0,1]
    s_branch L_rsj_21
L_rs3_25:
    ds_write_b128 v13, v[128:131] offset:0
    ds_write_b128 v13, v[132:135] offset:1024
    ds_write_b128 v14, v[136:139] offset:0
    ds_write_b128 v14, v[140:143] offset:1024
    ds_write_b128 v15, v[144:147] offset:0
    ds_write_b128 v15, v[148:151] offset:1024
    v_pk_mov_b32 v[160:161], v[152:153], v[152:153] op_sel:[0,1]
    v_pk_mov_b32 v[162:163], v[154:155], v[154:155] op_sel:[0,1]
    v_pk_mov_b32 v[164:165], v[156:157], v[156:157] op_sel:[0,1]
    v_pk_mov_b32 v[166:167], v[158:159], v[158:159] op_sel:[0,1]
L_rsj_21:
    s_nop 1
    s_waitcnt lgkmcnt(0)
    s_barrier
    ds_read_b128 v[32:35], v17 offset:0
    ds_read_b128 v[36:39], v17 offset:1024
    ds_read_b128 v[40:43], v18 offset:0
    ds_read_b128 v[44:47], v18 offset:1024
    ds_read_b128 v[48:51], v19 offset:0
    ds_read_b128 v[52:55], v19 offset:1024
    s_waitcnt lgkmcnt(5)
    v_pk_add_f32 v[160:161], v[160:161], v[32:33]
    v_pk_add_f32 v[162:163], v[162:163], v[34:35]
    s_waitcnt lgkmcnt(4)
    v_pk_add_f32 v[164:165], v[164:165], v[36:37]
    v_pk_add_f32 v[166:167], v[166:167], v[38:39]
    s_waitcnt lgkmcnt(1)
    v_pk_add_f32 v[40:41], v[40:41], v[48:49]
    v_pk_add_f32 v[42:43], v[42:43], v[50:51]
    s_waitcnt lgkmcnt(0)
    v_pk_add_f32 v[44:45], v[44:45], v[52:53]
    v_pk_add_f32 v[46:47], v[46:47], v[54:55]
    v_pk_add_f32 v[160:161], v[160:161], v[40:41]
    v_pk_add_f32 v[162:163], v[162:163], v[42:43]
    v_pk_add_f32 v[164:165], v[164:165], v[44:45]
    v_pk_add_f32 v[166:167], v[166:167], v[46:47]
    s_nop 0
    v_permlane32_swap_b32 v160, v164
    v_permlane32_swap_b32 v161, v165
    v_permlane32_swap_b32 v162, v166
    v_permlane32_swap_b32 v163, v167
    v_pk_add_f32 v[160:161], v[160:161], v[240:241]
    v_pk_add_f32 v[162:163], v[162:163], v[242:243]
    v_pk_add_f32 v[164:165], v[164:165], v[244:245]
    v_pk_add_f32 v[166:167], v[166:167], v[246:247]
    v_cvt_pk_bf16_f32 v56, v160, v161
    v_cvt_pk_bf16_f32 v57, v162, v163
    v_cvt_pk_bf16_f32 v58, v164, v165
    v_cvt_pk_bf16_f32 v59, v166, v167
    buffer_store_dwordx4 v[56:59], v31, s[84:87], 0 offen
L_end:
    s_endpgm
L_codeend:
.section .rodata,"a"
.p2align 6
.amdhsa_kernel parallel_sum__grouped_kv_mqa__dense_activation_gelu__prompt_kernel
  .amdhsa_next_free_vgpr 256
  .amdhsa_next_free_sgpr 102
  .amdhsa_accum_offset 256
  .amdhsa_group_segment_fixed_size 0
  .amdhsa_kernarg_size 104
  .amdhsa_user_sgpr_count 2
  .amdhsa_user_sgpr_kernarg_segment_ptr 1
  .amdhsa_system_sgpr_workgroup_id_x 1
.end_amdhsa_kernel
```
